```python
import torch

def _softmax(x, axis=-1):
    return torch.softmax(x, dim=axis)

def _gelu(x):
    return torch.nn.functional.gelu(x, approximate='tanh')

def _silu(x):
    return torch.nn.functional.silu(x)

def _sigmoid(x):
    return torch.sigmoid(x)

def _layernorm(x, axis=-1, eps=1e-05):
    m = x.mean(dim=axis, keepdim=True)
    v = x.var(dim=axis, keepdim=True, unbiased=False)
    return (x - m) / torch.sqrt(v + eps)

def _scatter_add(tgt, idx, src, axis=0):
    return tgt.clone().index_add_(axis, idx, src)

def _segment_sum(src, seg, n):
    out = torch.zeros((n,) + src.shape[1:], dtype=src.dtype)
    return out.index_add_(0, seg, src)

def _pad(x, pw):
    flat = tuple((v for pair in reversed(pw) for v in pair))
    return torch.nn.functional.pad(x, flat)
kernel_name = 'standalone__conformer_family_branchformer__speech'

def setup_inputs():

    _w = lambda a: (lambda t: t.to(torch.bfloat16) if t.is_floating_point() else t)(torch.as_tensor(a))
    B, T, D, K = (2, 4000, 144, 15)
    s = float(D) ** (-0.5)
    return {'x': _w((lambda *s: torch.randn(*s, dtype=torch.bfloat16) * 0.05)(B, T, D)), 'w_q': _w((lambda *s: torch.randn(*s, dtype=torch.bfloat16) * 1.6)(D, D) * s), 'w_k': _w((lambda *s: torch.randn(*s, dtype=torch.bfloat16) * 1.6)(D, D) * s), 'w_v': _w((lambda *s: torch.randn(*s, dtype=torch.bfloat16) * 0.4)(D, D) * s), 'w_ao': _w((lambda *s: torch.randn(*s, dtype=torch.bfloat16) * 0.4)(D, D) * s), 'w_up': _w((lambda *s: torch.randn(*s, dtype=torch.bfloat16) * 0.8)(D, 2 * D) * s), 'dw': _w((lambda *s: torch.randn(*s, dtype=torch.bfloat16) * 0.8)(K, D) * (1.0 / K)), 'w_dn': _w((lambda *s: torch.randn(*s, dtype=torch.bfloat16) * 0.4)(D, D) * s), 'w_merge': _w((lambda *s: torch.randn(*s, dtype=torch.bfloat16) * 0.4)(2 * D, D) * s)}

def reference(x, w_q, w_k, w_v, w_ao, w_up, dw, w_dn, w_merge):
    B, T, D = x.shape
    K = dw.shape[0]
    xa = _layernorm(x, axis=-1)
    q = torch.einsum('btd,de->bte', xa, w_q)
    k = torch.einsum('btd,de->bte', xa, w_k)
    v = torch.einsum('btd,de->bte', xa, w_v)
    logits = torch.einsum('btd,bsd->bts', q, k) * float(D) ** (-0.5)
    attn = _softmax(logits, axis=-1)
    ya = torch.einsum('bts,bsd->btd', attn, v)
    ya = torch.einsum('btd,de->bte', ya, w_ao)
    xc = _layernorm(x, axis=-1)
    h = _gelu(torch.einsum('btd,de->bte', xc, w_up))
    u = h[..., :D].clone()
    g = _layernorm(h[..., D:], axis=-1)
    pad = K // 2
    gp = _pad(g, ((0, 0), (pad, pad), (0, 0)))
    conv = torch.zeros_like(g)
    for i in range(K):
        conv = conv + gp[:, i:i + T, :] * dw[i][None, None, :]
    yc = torch.einsum('btd,de->bte', u * conv, w_dn)
    merged = torch.concatenate([ya, yc], axis=-1)
    out = torch.einsum('btf,fd->btd', merged, w_merge)
    return x + out
```

```asm
; @launch grid=(256,1,1) block=(256,1,1) lds=163840
.amdgcn_target "amdgcn-amd-amdhsa--gfx950"
.text
.globl standalone__conformer_family_branchformer__speech_kernel
.p2align 8
.type standalone__conformer_family_branchformer__speech_kernel,@function
standalone__conformer_family_branchformer__speech_kernel:
    s_cmp_ge_u32 s2, 256
    s_cbranch_scc1 Lk_end
    s_load_dwordx16 s[36:51], s[0:1], 0
    s_load_dwordx4 s[52:55], s[0:1], 64
    s_load_dwordx2 s[56:57], s[0:1], 88
    s_getpc_b64 s[62:63]
    v_lshrrev_b32 v8, 6, v0
    v_and_b32 v0, 63, v0
    s_and_b32 s62, s62, 0xffffff00
    s_lshr_b32 s60, s2, 3
    s_lshl_b32 s60, s60, 2
    v_add_u32 v1, s60, v8
    v_mul_u32_u24 v1, 2, v1
    v_add_u32 v1, v1, v0
    v_cmp_le_u32 vcc, 210, v1
    v_subrev_u32 v2, 210, v1
    s_nop 0
    v_cndmask_b32 v1, v1, v2, vcc
    v_min_u32 v1, 209, v1
    v_lshlrev_b32 v1, 7, v1
    global_load_dword v229, v1, s[62:63]
    s_cmp_ge_u32 s2, 126
    v_readfirstlane_b32 s16, v8
    s_cselect_b32 s17, 1, 0
    v_lshlrev_b32 v7, 4, v0
    s_mul_i32 s60, s17, 126
    s_sub_u32 s60, s2, s60
    s_lshr_b32 s18, s60, 1
    s_and_b32 s19, s60, 1
    s_mul_i32 s60, s17, 125
    s_lshl_b32 s61, s18, 1
    s_add_u32 s21, s60, s61
    s_lshl_b32 s22, s21, 5
    s_lshl_b32 s61, s16, 4
    s_add_u32 s22, s22, s61
    s_mul_i32 s60, s22, 288
    s_mul_i32 s61, s16, 5120
    s_add_u32 m0, s61, 125952
    s_add_u32 s64, s60, 4096
    s_mov_b32 s26, 2304000
    s_mov_b32 s27, 0x00020000
    s_waitcnt lgkmcnt(0)
    s_mov_b32 s24, s36
    s_mov_b32 s25, s37
    s_cmp_ge_u32 s2, 252
    s_cbranch_scc1 Lk_nox
    buffer_load_dwordx4 v7, s[24:27], s60 offen offset:0 lds
    buffer_load_dwordx4 v7, s[24:27], s60 offen offset:1024 lds
    buffer_load_dwordx4 v7, s[24:27], s60 offen offset:2048 lds
    buffer_load_dwordx4 v7, s[24:27], s60 offen offset:3072 lds
    s_add_u32 m0, s61, 130048
    s_mov_b32 exec_hi, 0
    buffer_load_dwordx4 v7, s[24:27], s64 offen lds
    s_mov_b64 exec, -1
Lk_nox:
    v_and_b32 v1, 15, v0
    v_lshrrev_b32 v2, 4, v0
    v_bfe_u32 v8, v0, 2, 2
    v_lshl_add_u32 v8, v2, 2, v8
    v_mul_u32_u24 v4, 288, v8
    v_and_b32 v8, 3, v0
    v_lshl_add_u32 v4, v8, 3, v4
    v_mul_u32_u24 v8, 288, v1
    v_lshl_add_u32 v5, v2, 4, v8
    v_lshl_add_u32 v6, v2, 3, v8
    v_add_u32 v6, 42240, v6
    v_add_u32 v5, 41984, v5
    s_mov_b32 s4, s56
    s_mov_b32 s5, s57
    s_mov_b32 s6, 268435456
    s_mov_b32 s7, 0x00020000
    s_add_u32 s60, s56, 11534336
    s_addc_u32 s61, s57, 0
    s_load_dword s58, s[60:61], 0
    s_cmp_ge_u32 s2, 252
    s_cbranch_scc1 Lw_start
    s_mov_b32 s28, s38
    s_mov_b32 s29, s39
    s_mov_b32 s30, 41472
    s_mov_b32 s31, 0x00020000
    s_mov_b32 s32, s40
    s_mov_b32 s33, s41
    s_mov_b32 s34, 41472
    s_mov_b32 s35, 0x00020000
    s_mov_b32 s24, s46
    s_mov_b32 s25, s47
    s_mov_b32 s26, 82944
    s_mov_b32 s27, 0x00020000
    s_lshr_b32 s60, s2, 3
    s_lshl_b32 s60, s60, 2
    s_add_u32 s60, s60, s16
    s_mul_i32 s61, s60, 384
    s_mul_i32 s62, s60, 768
    v_lshlrev_b32 v180, 7, v0
    s_mov_b64 exec, 7
    buffer_load_dword v229, v180, s[28:31], s61 offen
    buffer_load_dword v229, v180, s[32:35], s61 offen
    s_mov_b64 exec, 63
    buffer_load_dword v229, v180, s[24:27], s62 offen
    s_mov_b64 exec, -1
    s_mul_i32 s66, s16, 10240
    s_lshl_b32 s60, s19, 2
    s_add_u32 s60, s60, s16
    s_mul_i32 s61, s60, 125
    s_lshr_b32 s61, s61, 3
    s_add_u32 s62, s60, 1
    s_mul_i32 s62, s62, 125
    s_lshr_b32 s62, s62, 3
    s_sub_u32 s72, s62, s61
    s_sub_u32 s72, 16, s72
    s_mul_i32 s62, s17, 125
    s_add_u32 s80, s61, s62
    s_mul_i32 s12, s80, 9216
    s_mul_i32 s13, s16, 9216
    s_mov_b32 s14, 4
    s_cmp_eq_u32 s72, 0
    s_cselect_b32 s15, 9216, 0
    v_mov_b32 v220, v0
    v_mov_b32 v222, 0
    s_mov_b32 s59, 0
    s_add_u32 s79, s21, s19
    s_mul_i32 s77, s79, 9216
    s_add_u32 s60, s77, 5373952
    s_lshl_b32 s61, s18, 1
    s_add_u32 s61, s61, s19
    s_lshl_b32 s61, s61, 5
    s_mul_i32 s62, s17, 4016
    s_add_u32 s61, s61, s62
    s_add_u32 s61, s61, 1
    s_mul_i32 s61, s61, 288
    s_add_u32 s61, s61, 7864320
    s_cmp_eq_u32 s16, 0
    s_cselect_b32 s73, s60, s61
    s_add_u32 s61, s61, 9216
    s_cmp_eq_u32 s16, 2
    s_cselect_b32 s73, s61, s73
    s_cmp_eq_u32 s16, 3
    s_cselect_b32 s73, 10428416, s73
    s_add_u32 s74, s13, 10391552
    s_lshr_b32 s60, s16, 1
    s_cmp_eq_u32 s60, s19
    s_cselect_b32 s82, 1, 0
    s_cmp_eq_u32 s18, 62
    s_cselect_b32 s60, s19, 0
    s_cmp_eq_u32 s60, 1
    s_cselect_b32 s82, 0, s82
    s_cselect_b32 s83, 0, 1
    s_lshl_b32 s78, s79, 10
    s_and_b32 s61, s16, 1
    s_lshl_b32 s62, s61, 2
    s_add_u32 s78, s78, s62
    s_add_u32 s78, s78, 11599872
    s_lshl_b32 s62, s61, 4
    v_add_u32 v8, s62, v1
    v_lshlrev_b32 v9, 2, v2
    v_xor_b32 v9, v9, v8
    v_lshlrev_b32 v9, 4, v9
    v_lshl_add_u32 v177, v2, 9, v9
    v_lshrrev_b32 v10, 1, v2
    v_lshlrev_b32 v11, 2, v10
    v_xor_b32 v11, v11, v8
    v_lshlrev_b32 v11, 4, v11
    v_lshl_add_u32 v11, v10, 9, v11
    v_and_b32 v12, 1, v2
    v_lshl_add_u32 v11, v12, 3, v11
    v_add_u32 v179, 8192, v11
    v_add_u32 v178, 4096, v177
    v_bfe_u32 v8, v0, 2, 2
    v_cmp_eq_u32 vcc, v8, v2
    v_and_b32 v8, 1, v0
    v_lshlrev_b32 v8, 4, v8
    v_mov_b32 v9, 0x3f80
    v_lshlrev_b32 v9, v8, v9
    v_cndmask_b32 v9, 0, v9, vcc
    v_and_b32 v8, 2, v0
    v_cmp_eq_u32 vcc, 0, v8
    v_mov_b32 v230, 0x3f803f80
    v_mov_b32 v231, 0x3f803f80
    v_cndmask_b32 v182, 0, v9, vcc
    v_cndmask_b32_e64 v183, v9, 0, vcc
    v_mov_b32 v184, v182
    v_mov_b32 v185, v183
    v_mov_b32 v232, 0x3f803f80
    v_mov_b32 v233, 0x3f803f80
    v_mov_b32 v234, 0
    v_mov_b32 v235, 0
    v_mov_b32 v236, 0
    v_mov_b32 v237, 0
    v_mov_b32 v238, 0
    v_mov_b32 v239, 0
    v_mov_b32 v240, 0
    v_mov_b32 v241, 0
    v_mov_b32 v242, 0
    v_mov_b32 v243, 0
    v_mov_b32 v244, 0
    v_mov_b32 v245, 0
    s_nop 1
    v_mfma_f32_32x32x16_bf16 a[0:15], v[242:245], v[242:245], 0
    v_mfma_f32_32x32x16_bf16 a[16:31], v[242:245], v[242:245], 0
    v_mfma_f32_32x32x16_bf16 a[32:47], v[242:245], v[242:245], 0
    v_mfma_f32_32x32x16_bf16 a[48:63], v[242:245], v[242:245], 0
    v_mfma_f32_32x32x16_bf16 a[64:79], v[242:245], v[242:245], 0
    v_mfma_f32_32x32x16_bf16 a[80:95], v[242:245], v[242:245], 0
    v_mfma_f32_32x32x16_bf16 a[96:111], v[242:245], v[242:245], 0
    v_mfma_f32_32x32x16_bf16 a[112:127], v[242:245], v[242:245], 0
    v_mfma_f32_32x32x16_bf16 a[128:143], v[242:245], v[242:245], 0
    v_mfma_f32_32x32x16_bf16 a[144:159], v[242:245], v[242:245], 0
    s_add_u32 s67, s66, 0
    s_add_u32 m0, s67, 0
    s_nop 0
    buffer_load_dwordx4 v7, s[28:31], s67 offen offset:0 lds
    buffer_load_dwordx4 v7, s[28:31], s67 offen offset:1024 lds
    buffer_load_dwordx4 v7, s[28:31], s67 offen offset:2048 lds
    buffer_load_dwordx4 v7, s[28:31], s67 offen offset:3072 lds
    v_and_b32 v186, 31, v0
    v_lshrrev_b32 v187, 5, v0
    v_lshlrev_b32 v188, 2, v187
    v_add_u32 v188, 0, v188
    v_xor_b32 v188, v188, v186
    v_lshlrev_b32 v188, 4, v188
    v_lshl_add_u32 v188, v187, 9, v188
    v_add_u32 v190, s13, v188
    v_add_u32 v192, 73728, v190
    v_lshlrev_b32 v188, 2, v187
    v_add_u32 v188, 8, v188
    v_xor_b32 v188, v188, v186
    v_lshlrev_b32 v188, 4, v188
    v_lshl_add_u32 v188, v187, 9, v188
    v_add_u32 v191, s13, v188
    v_add_u32 v193, 73728, v191
    v_bfe_u32 v188, v0, 4, 1
    v_bfe_u32 v189, v0, 1, 1
    v_bfe_u32 v17, v0, 2, 2
    v_and_b32 v18, 1, v0
    v_xor_b32 v16, v187, v189
    v_lshl_add_u32 v17, v16, 2, v17
    v_lshlrev_b32 v20, 9, v189
    v_lshl_add_u32 v20, v18, 3, v20
    v_add_u32 v20, s13, v20
    v_xor_b32 v19, 0, v188
    v_lshl_add_u32 v19, v19, 3, v17
    v_lshl_add_u32 v194, v19, 4, v20
    v_add_u32 v196, 73728, v194
    v_xor_b32 v19, 1, v188
    v_lshl_add_u32 v19, v19, 3, v17
    v_lshl_add_u32 v195, v19, 4, v20
    v_add_u32 v197, 73728, v195
    v_lshlrev_b32 v206, 4, v0
    v_add_u32 v207, 4096, v206
    v_add_u32 v208, 8192, v206
    s_mul_i32 s60, s16, 10240
    v_add_u32 v8, s60, v7
    s_mov_b32 s61, 288
    v_add_u32 v9, 0, v8
    v_mul_u32_u24 v10, 58255, v9
    v_lshrrev_b32 v10, 24, v10
    v_add_u32 v9, 0, v8
    v_mad_u32_u24 v166, v10, s61, v9
    v_add_u32 v9, 1024, v8
    v_mul_u32_u24 v10, 58255, v9
    v_lshrrev_b32 v10, 24, v10
    v_add_u32 v9, 0, v8
    v_mad_u32_u24 v167, v10, s61, v9
    v_add_u32 v9, 2048, v8
    v_mul_u32_u24 v10, 58255, v9
    v_lshrrev_b32 v10, 24, v10
    v_add_u32 v9, 0, v8
    v_mad_u32_u24 v168, v10, s61, v9
    v_add_u32 v9, 3072, v8
    v_mul_u32_u24 v10, 58255, v9
    v_lshrrev_b32 v10, 24, v10
    v_add_u32 v9, 0, v8
    v_mad_u32_u24 v169, v10, s61, v9
    v_add_u32 v9, 4096, v8
    v_mul_u32_u24 v10, 58255, v9
    v_lshrrev_b32 v10, 24, v10
    v_add_u32 v9, 4096, v8
    v_mad_u32_u24 v170, v10, s61, v9
    v_add_u32 v9, 5120, v8
    v_mul_u32_u24 v10, 58255, v9
    v_lshrrev_b32 v10, 24, v10
    v_add_u32 v9, 4096, v8
    v_mad_u32_u24 v171, v10, s61, v9
    v_add_u32 v9, 6144, v8
    v_mul_u32_u24 v10, 58255, v9
    v_lshrrev_b32 v10, 24, v10
    v_add_u32 v9, 4096, v8
    v_mad_u32_u24 v172, v10, s61, v9
    v_add_u32 v9, 7168, v8
    v_mul_u32_u24 v10, 58255, v9
    v_lshrrev_b32 v10, 24, v10
    v_add_u32 v9, 4096, v8
    v_mad_u32_u24 v173, v10, s61, v9
    v_add_u32 v9, 8192, v8
    v_mul_u32_u24 v10, 58255, v9
    v_lshrrev_b32 v10, 24, v10
    v_add_u32 v9, 8192, v8
    v_mad_u32_u24 v174, v10, s61, v9
    v_add_u32 v9, 9216, v8
    v_mul_u32_u24 v10, 58255, v9
    v_lshrrev_b32 v10, 24, v10
    v_add_u32 v9, 8192, v8
    v_mad_u32_u24 v175, v10, s61, v9
    v_add_u32 v9, 10240, v8
    v_mul_u32_u24 v10, 58255, v9
    v_lshrrev_b32 v10, 24, v10
    v_add_u32 v9, 8192, v8
    v_mad_u32_u24 v176, v10, s61, v9
    s_add_u32 s60, s13, 110592
    v_mul_u32_u24 v246, 304, v1
    v_lshl_add_u32 v246, v2, 3, v246
    v_add_u32 v246, s60, v246
    v_add_u32 v8, s60, v7
    v_add_u32 v9, 0, v7
    v_mul_u32_u24 v9, 58255, v9
    v_lshrrev_b32 v9, 24, v9
    v_lshl_add_u32 v247, v9, 4, v8
    v_add_u32 v9, 1024, v7
    v_mul_u32_u24 v9, 58255, v9
    v_lshrrev_b32 v9, 24, v9
    v_lshl_add_u32 v248, v9, 4, v8
    v_add_u32 v9, 2048, v7
    v_mul_u32_u24 v9, 58255, v9
    v_lshrrev_b32 v9, 24, v9
    v_lshl_add_u32 v249, v9, 4, v8
    v_add_u32 v9, 3072, v7
    v_mul_u32_u24 v9, 58255, v9
    v_lshrrev_b32 v9, 24, v9
    v_lshl_add_u32 v250, v9, 4, v8
    v_add_u32 v9, 4096, v7
    v_mul_u32_u24 v9, 58255, v9
    v_lshrrev_b32 v9, 24, v9
    v_lshl_add_u32 v251, v9, 4, v8
    s_lshr_b32 s60, s16, 1
    s_mul_i32 s60, s60, 9216
    s_add_u32 s60, s60, 125952
    s_and_b32 s62, s16, 1
    s_lshl_b32 s62, s62, 4
    v_add_u32 v8, s62, v1
    v_lshlrev_b32 v8, 4, v8
    v_add_u32 v8, s60, v8
    v_lshrrev_b32 v10, 1, v2
    v_and_b32 v12, 1, v2
    v_lshl_add_u32 v186, v10, 10, v8
    v_lshl_add_u32 v186, v12, 9, v186
    v_lshl_add_u32 v187, v10, 9, v8
    v_lshl_add_u32 v187, v12, 3, v187
    s_lshl_b32 s60, s16, 6
    s_add_u32 s60, s60, 144384
    v_lshlrev_b32 v15, 2, v1
    v_add_u32 v188, s60, v15
    s_mul_i32 s60, s19, 9216
    s_add_u32 s60, s60, 125952
    s_sub_u32 s62, 261120, s60
    v_add_u32 v189, s60, v7
    v_add_u32 v209, s62, v7
    s_lshl_b32 s60, s19, 7
    v_and_b32 v10, 31, v0
    v_lshlrev_b32 v10, 2, v10
    v_add_u32 v10, 144384, v10
    v_add_u32 v212, s60, v10
    s_xor_b32 s60, s60, 128
    v_add_u32 v213, s60, v10
    s_and_b32 s60, s18, 7
    s_lshl_b32 s60, s60, 7
    s_lshl_b32 s62, s80, 10
    s_add_u32 s81, s60, s62
    s_add_u32 s81, s81, 11599872
    s_sub_u32 s60, 15, s72
    v_min_u32 v215, s60, v0
    v_lshlrev_b32 v215, 10, v215
    s_lshl_b32 s60, s19, 1
    s_add_u32 s60, s60, s17
    s_mul_i32 s60, s60, 252
    s_lshl_b32 s62, s18, 2
    s_add_u32 s60, s60, s62
    s_add_u32 s60, s60, s16
    s_lshl_b32 s60, s60, 7
    s_add_u32 s76, s60, 12189696
    s_and_b32 s60, s2, 31
    s_lshl_b32 s60, s60, 7
    s_add_u32 s63, s60, 11943912
    s_lshl_b32 s60, s18, 1
    s_add_u32 s60, s60, s19
    s_lshl_b32 s60, s60, 1
    v_min_u32 v8, 5, v0
    v_add_u32 v9, s60, v8
    v_add_u32 v10, -3, v9
    v_max_i32 v10, 0, v10
    v_min_u32 v10, 249, v10
    v_add_u32 v10, 504, v10
    v_cmp_gt_u32 vcc, 2, v8
    s_mul_i32 s62, s17, 252
    s_nop 0
    v_cndmask_b32 v9, v10, v9, vcc
    v_add_u32 v9, s62, v9
    v_lshlrev_b32 v9, 7, v9
    v_add_u32 v9, 12189696, v9
    v_min_u32 v10, 9, v0
    v_lshlrev_b32 v10, 2, v10
    v_add_u32 v10, s63, v10
    v_cmp_gt_u32 vcc, 6, v0
    s_mul_i32 s60, s17, 16
    s_add_u32 s60, s60, 8
    v_cndmask_b32 v216, v10, v9, vcc
    s_mul_i32 s60, s60, 288
    s_add_u32 s60, s60, 7864320
    s_cmp_eq_u32 s19, 1
    s_cselect_b32 s60, s60, 5373952
    s_mul_i32 s62, s22, 288
    s_add_u32 s60, s60, s62
    s_cmp_eq_u32 s18, 62
    s_cselect_b32 s62, s16, 0
    s_cmp_ge_u32 s62, 2
    s_cselect_b32 s75, 12058624, s60
    s_min_u32 s60, s79, 249
    s_mul_i32 s60, s60, 9216
    s_lshl_b32 s62, s16, 5
    s_add_u32 s71, s60, s62
    s_and_b32 s62, s16, 1
    s_mul_i32 s62, s62, 4608
    s_add_u32 s70, s60, s62
    s_add_u32 s70, s70, 256
    v_mul_u32_u24 v227, 288, v1
    v_lshl_add_u32 v227, v2, 3, v227
    v_add_u32 v228, 4608, v227
    s_mul_i32 s60, s16, 5120
    s_add_u32 s60, s60, 125952
    v_add_u32 v3, s60, v227
    v_add_u32 v22, 83968, v4
    s_mul_i32 s60, s19, 288
    s_add_u32 s24, s46, s60
    s_addc_u32 s25, s47, 0
    s_sub_u32 s26, 82944, s60
    s_mov_b32 s27, 0x00020000
    s_mul_i32 s66, s16, 10240
    s_mov_b32 s68, 0x3f803f80
    s_mov_b32 s69, 0xffff0000
    s_waitcnt lgkmcnt(0)
    s_add_u32 s20, s58, 1
    s_mul_i32 s20, s20, 0x9e3779b1
    v_mov_b32 v221, s20
    s_add_u32 s67, s66, 4096
    s_add_u32 m0, s67, 0
    s_nop 0
    buffer_load_dwordx4 v7, s[28:31], s67 offen offset:0 lds
    buffer_load_dwordx4 v7, s[28:31], s67 offen offset:1024 lds
    buffer_load_dwordx4 v7, s[28:31], s67 offen offset:2048 lds
    buffer_load_dwordx4 v7, s[28:31], s67 offen offset:3072 lds
    s_add_u32 s67, s66, 8192
    s_add_u32 m0, s67, 0
    s_nop 0
    buffer_load_dwordx4 v7, s[28:31], s67 offen offset:0 lds
    buffer_load_dwordx4 v7, s[28:31], s67 offen offset:1024 lds
    buffer_load_dwordx4 v7, s[28:31], s67 offen offset:2048 lds
    s_waitcnt vmcnt(14)
    ds_read_b64 v[84:85], v3 offset:0
    ds_read_b64 v[86:87], v3 offset:32
    ds_read_b64 v[88:89], v3 offset:64
    ds_read_b64 v[90:91], v3 offset:96
    ds_read_b64 v[92:93], v3 offset:128
    ds_read_b64 v[94:95], v3 offset:160
    ds_read_b64 v[96:97], v3 offset:192
    ds_read_b64 v[98:99], v3 offset:224
    ds_read_b64 v[100:101], v3 offset:256
    s_waitcnt lgkmcnt(0)
    v_dot2_f32_bf16 v8, v84, v230, 0
    v_dot2_f32_bf16 v10, v84, v84, 0
    v_dot2_f32_bf16 v9, v85, v230, 0
    v_dot2_f32_bf16 v11, v85, v85, 0
    v_dot2c_f32_bf16 v8, s68, v86
    v_dot2c_f32_bf16 v10, v86, v86
    v_dot2c_f32_bf16 v9, s68, v87
    v_dot2c_f32_bf16 v11, v87, v87
    v_dot2c_f32_bf16 v8, s68, v88
    v_dot2c_f32_bf16 v10, v88, v88
    v_dot2c_f32_bf16 v9, s68, v89
    v_dot2c_f32_bf16 v11, v89, v89
    v_dot2c_f32_bf16 v8, s68, v90
    v_dot2c_f32_bf16 v10, v90, v90
    v_dot2c_f32_bf16 v9, s68, v91
    v_dot2c_f32_bf16 v11, v91, v91
    v_dot2c_f32_bf16 v8, s68, v92
    v_dot2c_f32_bf16 v10, v92, v92
    v_dot2c_f32_bf16 v9, s68, v93
    v_dot2c_f32_bf16 v11, v93, v93
    v_dot2c_f32_bf16 v8, s68, v94
    v_dot2c_f32_bf16 v10, v94, v94
    v_dot2c_f32_bf16 v9, s68, v95
    v_dot2c_f32_bf16 v11, v95, v95
    v_dot2c_f32_bf16 v8, s68, v96
    v_dot2c_f32_bf16 v10, v96, v96
    v_dot2c_f32_bf16 v9, s68, v97
    v_dot2c_f32_bf16 v11, v97, v97
    v_dot2c_f32_bf16 v8, s68, v98
    v_dot2c_f32_bf16 v10, v98, v98
    v_dot2c_f32_bf16 v9, s68, v99
    v_dot2c_f32_bf16 v11, v99, v99
    v_dot2c_f32_bf16 v8, s68, v100
    v_dot2c_f32_bf16 v10, v100, v100
    v_dot2c_f32_bf16 v9, s68, v101
    v_dot2c_f32_bf16 v11, v101, v101
    s_nop 1
    v_add_f32 v8, v8, v9
    v_add_f32 v10, v10, v11
    v_lshlrev_b32 v24, 16, v84
    v_and_b32 v25, s69, v84
    v_permlane32_swap_b32 v8, v10
    v_add_f32 v8, v8, v10
    v_mov_b32 v10, v8
    v_lshlrev_b32 v26, 16, v85
    v_and_b32 v27, s69, v85
    v_permlane16_swap_b32 v8, v10
    v_add_f32 v8, v8, v10
    v_mov_b32 v10, v8
    v_lshlrev_b32 v28, 16, v86
    v_and_b32 v29, s69, v86
    v_permlane32_swap_b32 v8, v10
    v_mul_f32 v8, 0x3be38e39, v8
    v_mul_f32 v10, 0x3be38e39, v10
    v_lshlrev_b32 v30, 16, v87
    v_fma_f32 v10, -v8, v8, v10
    v_max_f32 v10, 0, v10
    v_add_f32 v10, 0x3727c5ac, v10
    v_rsq_f32 v16, v10
    v_and_b32 v31, s69, v87
    v_mul_f32 v18, v8, v16
    v_mov_b32 v17, v16
    v_sub_f32 v18, 0, v18
    v_mov_b32 v19, v18
    v_lshlrev_b32 v32, 16, v88
    v_and_b32 v33, s69, v88
    v_lshlrev_b32 v34, 16, v89
    v_and_b32 v35, s69, v89
    v_lshlrev_b32 v36, 16, v90
    v_and_b32 v37, s69, v90
    v_lshlrev_b32 v38, 16, v91
    v_and_b32 v39, s69, v91
    v_lshlrev_b32 v40, 16, v92
    v_and_b32 v41, s69, v92
    v_lshlrev_b32 v42, 16, v93
    v_and_b32 v43, s69, v93
    v_lshlrev_b32 v44, 16, v94
    v_and_b32 v45, s69, v94
    v_lshlrev_b32 v46, 16, v95
    v_and_b32 v47, s69, v95
    v_lshlrev_b32 v48, 16, v96
    v_and_b32 v49, s69, v96
    v_lshlrev_b32 v50, 16, v97
    v_and_b32 v51, s69, v97
    v_lshlrev_b32 v52, 16, v98
    v_and_b32 v53, s69, v98
    v_lshlrev_b32 v54, 16, v99
    v_and_b32 v55, s69, v99
    v_lshlrev_b32 v56, 16, v100
    v_and_b32 v57, s69, v100
    v_lshlrev_b32 v58, 16, v101
    v_and_b32 v59, s69, v101
    v_pk_fma_f32 v[24:25], v[24:25], v[16:17], v[18:19]
    v_pk_fma_f32 v[26:27], v[26:27], v[16:17], v[18:19]
    v_cvt_pk_bf16_f32 v140, v24, v25
    v_pk_fma_f32 v[28:29], v[28:29], v[16:17], v[18:19]
    v_cvt_pk_bf16_f32 v141, v26, v27
    v_pk_fma_f32 v[30:31], v[30:31], v[16:17], v[18:19]
    v_cvt_pk_bf16_f32 v142, v28, v29
    v_pk_fma_f32 v[32:33], v[32:33], v[16:17], v[18:19]
    v_cvt_pk_bf16_f32 v143, v30, v31
    v_pk_fma_f32 v[34:35], v[34:35], v[16:17], v[18:19]
    v_cvt_pk_bf16_f32 v144, v32, v33
    v_pk_fma_f32 v[36:37], v[36:37], v[16:17], v[18:19]
    v_cvt_pk_bf16_f32 v145, v34, v35
    v_pk_fma_f32 v[38:39], v[38:39], v[16:17], v[18:19]
    v_cvt_pk_bf16_f32 v146, v36, v37
    v_pk_fma_f32 v[40:41], v[40:41], v[16:17], v[18:19]
    v_cvt_pk_bf16_f32 v147, v38, v39
    v_pk_fma_f32 v[42:43], v[42:43], v[16:17], v[18:19]
    v_cvt_pk_bf16_f32 v148, v40, v41
    v_pk_fma_f32 v[44:45], v[44:45], v[16:17], v[18:19]
    v_cvt_pk_bf16_f32 v149, v42, v43
    v_pk_fma_f32 v[46:47], v[46:47], v[16:17], v[18:19]
    v_cvt_pk_bf16_f32 v150, v44, v45
    v_pk_fma_f32 v[48:49], v[48:49], v[16:17], v[18:19]
    v_cvt_pk_bf16_f32 v151, v46, v47
    v_pk_fma_f32 v[50:51], v[50:51], v[16:17], v[18:19]
    v_cvt_pk_bf16_f32 v152, v48, v49
    v_pk_fma_f32 v[52:53], v[52:53], v[16:17], v[18:19]
    v_cvt_pk_bf16_f32 v153, v50, v51
    v_pk_fma_f32 v[54:55], v[54:55], v[16:17], v[18:19]
    v_cvt_pk_bf16_f32 v154, v52, v53
    v_pk_fma_f32 v[56:57], v[56:57], v[16:17], v[18:19]
    v_cvt_pk_bf16_f32 v155, v54, v55
    v_pk_fma_f32 v[58:59], v[58:59], v[16:17], v[18:19]
    v_cvt_pk_bf16_f32 v156, v56, v57
    v_cvt_pk_bf16_f32 v157, v58, v59
    s_cmp_eq_u32 s82, 0
    s_cbranch_scc1 Lp_nopub
    buffer_store_dwordx4 v[140:143], v177, s[4:7], s77 offen offset:0 sc1
    buffer_store_dwordx4 v[144:147], v177, s[4:7], s77 offen offset:2048 sc1
    buffer_store_dwordx4 v[148:151], v178, s[4:7], s77 offen offset:0 sc1
    buffer_store_dwordx4 v[152:155], v178, s[4:7], s77 offen offset:2048 sc1
    buffer_store_dwordx2 v[156:157], v179, s[4:7], s77 offen sc1
    s_waitcnt vmcnt(5)
    s_branch Lp_pub2
Lp_nopub:
    s_waitcnt vmcnt(0)
Lp_pub2:
    s_barrier
    ds_read_b64_tr_b16 v[24:25], v4 offset:0
    ds_read_b64_tr_b16 v[26:27], v4 offset:4608
    ds_read_b64_tr_b16 v[28:29], v4 offset:9216
    ds_read_b64_tr_b16 v[30:31], v4 offset:13824
    ds_read_b64_tr_b16 v[32:33], v4 offset:18432
    ds_read_b64_tr_b16 v[34:35], v4 offset:23040
    ds_read_b64_tr_b16 v[36:37], v4 offset:27648
    ds_read_b64_tr_b16 v[38:39], v4 offset:32256
    ds_read_b64_tr_b16 v[72:73], v4 offset:36864
    ds_read_b64_tr_b16 v[40:41], v4 offset:32
    ds_read_b64_tr_b16 v[42:43], v4 offset:4640
    ds_read_b64_tr_b16 v[44:45], v4 offset:9248
    ds_read_b64_tr_b16 v[46:47], v4 offset:13856
    ds_read_b64_tr_b16 v[48:49], v4 offset:18464
    ds_read_b64_tr_b16 v[50:51], v4 offset:23072
    ds_read_b64_tr_b16 v[52:53], v4 offset:27680
    ds_read_b64_tr_b16 v[54:55], v4 offset:32288
    ds_read_b64_tr_b16 v[74:75], v4 offset:36896
    s_waitcnt lgkmcnt(9)
    v_mfma_f32_16x16x32_bf16 v[84:87], v[24:27], v[140:143], 0
    ds_read_b64_tr_b16 v[56:57], v4 offset:64
    ds_read_b64_tr_b16 v[58:59], v4 offset:4672
    ds_read_b64_tr_b16 v[60:61], v4 offset:9280
    v_mfma_f32_16x16x32_bf16 v[84:87], v[28:31], v[144:147], v[84:87]
    ds_read_b64_tr_b16 v[62:63], v4 offset:13888
    ds_read_b64_tr_b16 v[64:65], v4 offset:18496
    v_mfma_f32_16x16x32_bf16 v[84:87], v[32:35], v[148:151], v[84:87]
    ds_read_b64_tr_b16 v[66:67], v4 offset:23104
    ds_read_b64_tr_b16 v[68:69], v4 offset:27712
    s_add_u32 s67, s66, 0
    s_add_u32 m0, s67, 41984
    s_nop 0
    buffer_load_dwordx4 v7, s[32:35], s67 offen offset:0 lds
    buffer_load_dwordx4 v7, s[32:35], s67 offen offset:1024 lds
    buffer_load_dwordx4 v7, s[32:35], s67 offen offset:2048 lds
    v_mfma_f32_16x16x32_bf16 v[84:87], v[36:39], v[152:155], v[84:87]
    ds_read_b64_tr_b16 v[70:71], v4 offset:32320
    ds_read_b64_tr_b16 v[76:77], v4 offset:36928
    s_waitcnt lgkmcnt(9)
    v_mfma_f32_16x16x32_bf16 v[88:91], v[40:43], v[140:143], 0
    ds_read_b64_tr_b16 v[24:25], v4 offset:96
    ds_read_b64_tr_b16 v[26:27], v4 offset:4704
    v_mfma_f32_16x16x32_bf16 v[88:91], v[44:47], v[144:147], v[88:91]
    ds_read_b64_tr_b16 v[28:29], v4 offset:9312
    ds_read_b64_tr_b16 v[30:31], v4 offset:13920
    v_mfma_f32_16x16x16_bf16 v[84:87], v[72:73], v[156:157], v[84:87]
    ds_read_b64_tr_b16 v[32:33], v4 offset:18528
    ds_read_b64_tr_b16 v[34:35], v4 offset:23136
    v_mfma_f32_16x16x32_bf16 v[88:91], v[48:51], v[148:151], v[88:91]
    ds_read_b64_tr_b16 v[36:37], v4 offset:27744
    ds_read_b64_tr_b16 v[38:39], v4 offset:32352
    buffer_load_dwordx4 v7, s[32:35], s67 offen offset:3072 lds
    s_add_u32 s67, s66, 4096
    s_add_u32 m0, s67, 41984
    s_nop 0
    buffer_load_dwordx4 v7, s[32:35], s67 offen offset:0 lds
    buffer_load_dwordx4 v7, s[32:35], s67 offen offset:1024 lds
    v_mfma_f32_16x16x32_bf16 v[88:91], v[52:55], v[152:155], v[88:91]
    ds_read_b64_tr_b16 v[78:79], v4 offset:36960
    s_waitcnt lgkmcnt(9)
    v_mfma_f32_16x16x32_bf16 v[92:95], v[56:59], v[140:143], 0
    ds_read_b64_tr_b16 v[40:41], v4 offset:128
    ds_read_b64_tr_b16 v[42:43], v4 offset:4736
    v_mfma_f32_16x16x32_bf16 v[92:95], v[60:63], v[144:147], v[92:95]
    ds_read_b64_tr_b16 v[44:45], v4 offset:9344
    ds_read_b64_tr_b16 v[46:47], v4 offset:13952
    v_mfma_f32_16x16x16_bf16 v[88:91], v[74:75], v[156:157], v[88:91]
    ds_read_b64_tr_b16 v[48:49], v4 offset:18560
    ds_read_b64_tr_b16 v[50:51], v4 offset:23168
    v_mfma_f32_16x16x32_bf16 v[92:95], v[64:67], v[148:151], v[92:95]
    ds_read_b64_tr_b16 v[52:53], v4 offset:27776
    ds_read_b64_tr_b16 v[54:55], v4 offset:32384
    buffer_load_dwordx4 v7, s[32:35], s67 offen offset:2048 lds
    buffer_load_dwordx4 v7, s[32:35], s67 offen offset:3072 lds
    s_add_u32 s67, s66, 8192
    s_add_u32 m0, s67, 41984
    s_nop 0
    buffer_load_dwordx4 v7, s[32:35], s67 offen offset:0 lds
    v_mfma_f32_16x16x32_bf16 v[92:95], v[68:71], v[152:155], v[92:95]
    ds_read_b64_tr_b16 v[72:73], v4 offset:36992
    s_waitcnt lgkmcnt(9)
    v_mfma_f32_16x16x32_bf16 v[96:99], v[24:27], v[140:143], 0
    ds_read_b64_tr_b16 v[56:57], v4 offset:160
    ds_read_b64_tr_b16 v[58:59], v4 offset:4768
    v_mfma_f32_16x16x32_bf16 v[96:99], v[28:31], v[144:147], v[96:99]
    ds_read_b64_tr_b16 v[60:61], v4 offset:9376
    ds_read_b64_tr_b16 v[62:63], v4 offset:13984
    v_mfma_f32_16x16x16_bf16 v[92:95], v[76:77], v[156:157], v[92:95]
    ds_read_b64_tr_b16 v[64:65], v4 offset:18592
    ds_read_b64_tr_b16 v[66:67], v4 offset:23200
    v_mfma_f32_16x16x32_bf16 v[96:99], v[32:35], v[148:151], v[96:99]
    ds_read_b64_tr_b16 v[68:69], v4 offset:27808
    ds_read_b64_tr_b16 v[70:71], v4 offset:32416
    buffer_load_dwordx4 v7, s[32:35], s67 offen offset:1024 lds
    buffer_load_dwordx4 v7, s[32:35], s67 offen offset:2048 lds
    v_mfma_f32_16x16x32_bf16 v[96:99], v[36:39], v[152:155], v[96:99]
    ds_read_b64_tr_b16 v[74:75], v4 offset:37024
    s_waitcnt lgkmcnt(9)
    v_mfma_f32_16x16x32_bf16 v[100:103], v[40:43], v[140:143], 0
    ds_read_b64_tr_b16 v[24:25], v4 offset:192
    ds_read_b64_tr_b16 v[26:27], v4 offset:4800
    v_mfma_f32_16x16x32_bf16 v[100:103], v[44:47], v[144:147], v[100:103]
    ds_read_b64_tr_b16 v[28:29], v4 offset:9408
    ds_read_b64_tr_b16 v[30:31], v4 offset:14016
    v_mfma_f32_16x16x16_bf16 v[96:99], v[78:79], v[156:157], v[96:99]
    ds_read_b64_tr_b16 v[32:33], v4 offset:18624
    ds_read_b64_tr_b16 v[34:35], v4 offset:23232
    v_mfma_f32_16x16x32_bf16 v[100:103], v[48:51], v[148:151], v[100:103]
    ds_read_b64_tr_b16 v[36:37], v4 offset:27840
    ds_read_b64_tr_b16 v[38:39], v4 offset:32448
    s_add_u32 m0, s66, 83968
    s_nop 0
    buffer_load_dwordx4 v166, s[24:27], 0 offen offset:0 lds
    buffer_load_dwordx4 v167, s[24:27], 0 offen offset:1024 lds
    buffer_load_dwordx4 v168, s[24:27], 0 offen offset:2048 lds
    v_mfma_f32_16x16x32_bf16 v[100:103], v[52:55], v[152:155], v[100:103]
    ds_read_b64_tr_b16 v[76:77], v4 offset:37056
    s_waitcnt lgkmcnt(9)
    v_mfma_f32_16x16x32_bf16 v[104:107], v[56:59], v[140:143], 0
    ds_read_b64_tr_b16 v[40:41], v4 offset:224
    ds_read_b64_tr_b16 v[42:43], v4 offset:4832
    v_mfma_f32_16x16x32_bf16 v[104:107], v[60:63], v[144:147], v[104:107]
    ds_read_b64_tr_b16 v[44:45], v4 offset:9440
    ds_read_b64_tr_b16 v[46:47], v4 offset:14048
    v_mfma_f32_16x16x16_bf16 v[100:103], v[72:73], v[156:157], v[100:103]
    ds_read_b64_tr_b16 v[48:49], v4 offset:18656
    ds_read_b64_tr_b16 v[50:51], v4 offset:23264
    v_mfma_f32_16x16x32_bf16 v[104:107], v[64:67], v[148:151], v[104:107]
    ds_read_b64_tr_b16 v[52:53], v4 offset:27872
    ds_read_b64_tr_b16 v[54:55], v4 offset:32480
    buffer_load_dwordx4 v169, s[24:27], 0 offen offset:3072 lds
    s_add_u32 m0, s66, 88064
    s_nop 0
    buffer_load_dwordx4 v170, s[24:27], 0 offen offset:0 lds
    v_mfma_f32_16x16x32_bf16 v[104:107], v[68:71], v[152:155], v[104:107]
    ds_read_b64_tr_b16 v[78:79], v4 offset:37088
    s_cmp_eq_u32 s82, 0
    s_cbranch_scc1 Lp_nomid
    s_waitcnt vmcnt(16)
    s_mov_b64 exec, 0xff
    buffer_store_dword v221, v180, s[4:7], s78 offen sc1
    s_mov_b64 exec, -1
Lp_nomid:
    s_nop 3
    s_waitcnt lgkmcnt(9)
    v_mfma_f32_16x16x32_bf16 v[108:111], v[24:27], v[140:143], 0
    ds_read_b64_tr_b16 v[56:57], v4 offset:256
    ds_read_b64_tr_b16 v[58:59], v4 offset:4864
    v_mfma_f32_16x16x32_bf16 v[108:111], v[28:31], v[144:147], v[108:111]
    ds_read_b64_tr_b16 v[60:61], v4 offset:9472
    ds_read_b64_tr_b16 v[62:63], v4 offset:14080
    v_mfma_f32_16x16x16_bf16 v[104:107], v[74:75], v[156:157], v[104:107]
    ds_read_b64_tr_b16 v[64:65], v4 offset:18688
    ds_read_b64_tr_b16 v[66:67], v4 offset:23296
    v_mfma_f32_16x16x32_bf16 v[108:111], v[32:35], v[148:151], v[108:111]
    ds_read_b64_tr_b16 v[68:69], v4 offset:27904
    ds_read_b64_tr_b16 v[70:71], v4 offset:32512
    buffer_load_dwordx4 v171, s[24:27], 0 offen offset:1024 lds
    buffer_load_dwordx4 v172, s[24:27], 0 offen offset:2048 lds
    v_mfma_f32_16x16x32_bf16 v[108:111], v[36:39], v[152:155], v[108:111]
    ds_read_b64_tr_b16 v[72:73], v4 offset:37120
    s_waitcnt lgkmcnt(9)
    v_mfma_f32_16x16x32_bf16 v[112:115], v[40:43], v[140:143], 0
    v_mfma_f32_16x16x32_bf16 v[112:115], v[44:47], v[144:147], v[112:115]
    s_nop 1
    v_mfma_f32_16x16x16_bf16 v[108:111], v[76:77], v[156:157], v[108:111]
    v_mfma_f32_16x16x32_bf16 v[112:115], v[48:51], v[148:151], v[112:115]
    buffer_load_dwordx4 v173, s[24:27], 0 offen offset:3072 lds
    s_add_u32 m0, s66, 92160
    s_nop 0
    buffer_load_dwordx4 v174, s[24:27], 0 offen offset:0 lds
    v_mfma_f32_16x16x32_bf16 v[112:115], v[52:55], v[152:155], v[112:115]
    s_waitcnt lgkmcnt(0)
    v_mfma_f32_16x16x32_bf16 v[116:119], v[56:59], v[140:143], 0
    v_mfma_f32_16x16x32_bf16 v[116:119], v[60:63], v[144:147], v[116:119]
    s_nop 2
    v_mfma_f32_16x16x16_bf16 v[112:115], v[78:79], v[156:157], v[112:115]
    v_mfma_f32_16x16x32_bf16 v[116:119], v[64:67], v[148:151], v[116:119]
    buffer_load_dwordx4 v175, s[24:27], 0 offen offset:1024 lds
    buffer_load_dwordx4 v176, s[24:27], 0 offen offset:2048 lds
    v_mfma_f32_16x16x32_bf16 v[116:119], v[68:71], v[152:155], v[116:119]
    s_nop 5
    v_mfma_f32_16x16x16_bf16 v[116:119], v[72:73], v[156:157], v[116:119]
    v_cvt_pk_bf16_f32 v120, v84, v85
    v_cvt_pk_bf16_f32 v121, v86, v87
    v_cvt_pk_bf16_f32 v122, v88, v89
    v_cvt_pk_bf16_f32 v123, v90, v91
    v_cvt_pk_bf16_f32 v124, v92, v93
    v_cvt_pk_bf16_f32 v125, v94, v95
    v_cvt_pk_bf16_f32 v126, v96, v97
    v_cvt_pk_bf16_f32 v127, v98, v99
    v_cvt_pk_bf16_f32 v128, v100, v101
    v_cvt_pk_bf16_f32 v129, v102, v103
    v_cvt_pk_bf16_f32 v130, v104, v105
    v_cvt_pk_bf16_f32 v131, v106, v107
    v_cvt_pk_bf16_f32 v132, v108, v109
    v_cvt_pk_bf16_f32 v133, v110, v111
    v_cvt_pk_bf16_f32 v134, v112, v113
    v_cvt_pk_bf16_f32 v135, v114, v115
    v_cvt_pk_bf16_f32 v136, v116, v117
    v_cvt_pk_bf16_f32 v137, v118, v119
    v_permlane32_swap_b32 v120, v122
    v_permlane32_swap_b32 v121, v123
    v_permlane32_swap_b32 v124, v126
    v_permlane32_swap_b32 v125, v127
    v_permlane32_swap_b32 v128, v130
    v_permlane32_swap_b32 v129, v131
    v_permlane32_swap_b32 v132, v134
    v_permlane32_swap_b32 v133, v135
    v_permlane16_swap_b32 v120, v122
    v_permlane16_swap_b32 v121, v123
    v_permlane16_swap_b32 v124, v126
    v_permlane16_swap_b32 v125, v127
    v_permlane16_swap_b32 v128, v130
    v_permlane16_swap_b32 v129, v131
    v_permlane16_swap_b32 v132, v134
    v_permlane16_swap_b32 v133, v135
    s_cmp_eq_u32 s82, 0
    s_cbranch_scc1 Lp_noflag0
    s_waitcnt vmcnt(12)
    s_branch Lp_noflag
Lp_noflag0:
    s_waitcnt vmcnt(11)
Lp_noflag:
    s_barrier
    s_mov_b32 s69, 0x3df6384f
    s_mov_b32 s28, s36
    s_mov_b32 s29, s37
    s_mov_b32 s30, 2304000
    s_mov_b32 s31, 0x00020000
    ds_read_b128 v[24:27], v5 offset:0
    ds_read_b128 v[28:31], v5 offset:64
    ds_read_b128 v[32:35], v5 offset:128
    ds_read_b128 v[36:39], v5 offset:192
    ds_read_b64 v[72:73], v6 offset:0
    ds_read_b128 v[40:43], v5 offset:4608
    ds_read_b128 v[44:47], v5 offset:4672
    ds_read_b128 v[48:51], v5 offset:4736
    ds_read_b128 v[52:55], v5 offset:4800
    ds_read_b64 v[74:75], v6 offset:4608
    s_waitcnt lgkmcnt(5)
    v_mfma_f32_16x16x32_bf16 v[84:87], v[24:27], v[120:123], 0
    ds_read_b128 v[56:59], v5 offset:9216
    ds_read_b128 v[60:63], v5 offset:9280
    v_mfma_f32_16x16x32_bf16 v[84:87], v[28:31], v[124:127], v[84:87]
    ds_read_b128 v[64:67], v5 offset:9344
    v_mfma_f32_16x16x32_bf16 v[84:87], v[32:35], v[128:131], v[84:87]
    ds_read_b128 v[68:71], v5 offset:9408
    v_mfma_f32_16x16x32_bf16 v[84:87], v[36:39], v[132:135], v[84:87]
    ds_read_b64 v[76:77], v6 offset:9216
    s_waitcnt lgkmcnt(5)
    v_mfma_f32_16x16x32_bf16 v[88:91], v[40:43], v[120:123], 0
    ds_read_b128 v[24:27], v5 offset:13824
    v_mfma_f32_16x16x32_bf16 v[88:91], v[44:47], v[124:127], v[88:91]
    ds_read_b128 v[28:31], v5 offset:13888
    v_mfma_f32_16x16x16_bf16 v[84:87], v[72:73], v[136:137], v[84:87]
    ds_read_b128 v[32:35], v5 offset:13952
    v_mfma_f32_16x16x32_bf16 v[88:91], v[48:51], v[128:131], v[88:91]
    ds_read_b128 v[36:39], v5 offset:14016
    v_mfma_f32_16x16x32_bf16 v[88:91], v[52:55], v[132:135], v[88:91]
    ds_read_b64 v[78:79], v6 offset:13824
    s_waitcnt lgkmcnt(5)
    v_mfma_f32_16x16x32_bf16 v[92:95], v[56:59], v[120:123], 0
    ds_read_b128 v[40:43], v5 offset:18432
    ds_read_b128 v[44:47], v5 offset:18496
    ds_read_b128 v[48:51], v5 offset:18560
    v_mfma_f32_16x16x32_bf16 v[92:95], v[60:63], v[124:127], v[92:95]
    ds_read_b128 v[52:55], v5 offset:18624
    ds_read_b64 v[72:73], v6 offset:18432
    v_mfma_f32_16x16x16_bf16 v[88:91], v[74:75], v[136:137], v[88:91]
    v_mul_f32 v84, s69, v84
    v_mul_f32 v85, s69, v85
    v_mfma_f32_16x16x32_bf16 v[92:95], v[64:67], v[128:131], v[92:95]
    v_mul_f32 v86, s69, v86
    v_mul_f32 v87, s69, v87
    v_mfma_f32_16x16x32_bf16 v[92:95], v[68:71], v[132:135], v[92:95]
    v_cvt_pk_bf16_f32 v84, v84, v85
    v_cvt_pk_bf16_f32 v85, v86, v87
    s_waitcnt lgkmcnt(5)
    v_mfma_f32_16x16x32_bf16 v[96:99], v[24:27], v[120:123], 0
    ds_read_b128 v[56:59], v5 offset:23040
    ds_read_b128 v[60:63], v5 offset:23104
    ds_read_b128 v[64:67], v5 offset:23168
    v_mfma_f32_16x16x32_bf16 v[96:99], v[28:31], v[124:127], v[96:99]
    ds_read_b128 v[68:71], v5 offset:23232
    ds_read_b64 v[74:75], v6 offset:23040
    v_mfma_f32_16x16x16_bf16 v[92:95], v[76:77], v[136:137], v[92:95]
    v_mul_f32 v88, s69, v88
    v_mul_f32 v89, s69, v89
    v_mfma_f32_16x16x32_bf16 v[96:99], v[32:35], v[128:131], v[96:99]
    v_mul_f32 v90, s69, v90
    v_mul_f32 v91, s69, v91
    v_mfma_f32_16x16x32_bf16 v[96:99], v[36:39], v[132:135], v[96:99]
    v_cvt_pk_bf16_f32 v86, v88, v89
    v_cvt_pk_bf16_f32 v87, v90, v91
    s_waitcnt lgkmcnt(5)
    v_mfma_f32_16x16x32_bf16 v[100:103], v[40:43], v[120:123], 0
    ds_read_b128 v[24:27], v5 offset:27648
    ds_read_b128 v[28:31], v5 offset:27712
    ds_read_b128 v[32:35], v5 offset:27776
    v_mfma_f32_16x16x32_bf16 v[100:103], v[44:47], v[124:127], v[100:103]
    ds_read_b128 v[36:39], v5 offset:27840
    ds_read_b64 v[76:77], v6 offset:27648
    v_mul_f32 v92, s69, v92
    v_mfma_f32_16x16x16_bf16 v[96:99], v[78:79], v[136:137], v[96:99]
    v_mul_f32 v93, s69, v93
    ds_write_b128 v186, v[84:87] offset:0
    v_mul_f32 v94, s69, v94
    v_mfma_f32_16x16x32_bf16 v[100:103], v[48:51], v[128:131], v[100:103]
    v_mfma_f32_16x16x32_bf16 v[80:83], v[140:143], v[84:87], 0
    v_mul_f32 v95, s69, v95
    buffer_load_dwordx2 a[232:233], v227, s[28:31], s71 offen offset:0
    v_mfma_f32_16x16x32_bf16 v[100:103], v[52:55], v[132:135], v[100:103]
    v_cvt_pk_bf16_f32 v92, v92, v93
    v_cvt_pk_bf16_f32 v93, v94, v95
    s_waitcnt lgkmcnt(5)
    v_mfma_f32_16x16x32_bf16 v[104:107], v[56:59], v[120:123], 0
    ds_read_b128 v[40:43], v5 offset:32256
    ds_read_b128 v[44:47], v5 offset:32320
    ds_read_b128 v[48:51], v5 offset:32384
    v_mfma_f32_16x16x32_bf16 v[104:107], v[60:63], v[124:127], v[104:107]
    ds_read_b128 v[52:55], v5 offset:32448
    ds_read_b64 v[78:79], v6 offset:32256
    v_mfma_f32_16x16x16_bf16 v[100:103], v[72:73], v[136:137], v[100:103]
    v_mul_f32 v96, s69, v96
    v_mul_f32 v97, s69, v97
    v_mfma_f32_16x16x32_bf16 v[104:107], v[64:67], v[128:131], v[104:107]
    v_mul_f32 v98, s69, v98
    v_mul_f32 v99, s69, v99
    buffer_load_dwordx2 a[234:235], v228, s[28:31], s71 offen offset:0
    v_mfma_f32_16x16x32_bf16 v[104:107], v[68:71], v[132:135], v[104:107]
    v_cvt_pk_bf16_f32 v94, v96, v97
    v_cvt_pk_bf16_f32 v95, v98, v99
    s_waitcnt lgkmcnt(5)
    v_mfma_f32_16x16x32_bf16 v[108:111], v[24:27], v[120:123], 0
    ds_read_b128 v[56:59], v5 offset:36864
    ds_read_b128 v[60:63], v5 offset:36928
    ds_read_b128 v[64:67], v5 offset:36992
    v_mfma_f32_16x16x32_bf16 v[108:111], v[28:31], v[124:127], v[108:111]
    ds_read_b128 v[68:71], v5 offset:37056
    ds_read_b64 v[72:73], v6 offset:36864
    v_mul_f32 v100, s69, v100
    v_mfma_f32_16x16x16_bf16 v[104:107], v[74:75], v[136:137], v[104:107]
    v_mul_f32 v101, s69, v101
    ds_write_b128 v186, v[92:95] offset:2048
    v_mul_f32 v102, s69, v102
    v_mfma_f32_16x16x32_bf16 v[108:111], v[32:35], v[128:131], v[108:111]
    v_mfma_f32_16x16x32_bf16 v[80:83], v[144:147], v[92:95], v[80:83]
    v_mul_f32 v103, s69, v103
    buffer_load_dwordx2 a[236:237], v227, s[28:31], s71 offen offset:128
    buffer_load_dwordx2 v[210:211], v215, s[4:7], s81 offen sc1
    v_mfma_f32_16x16x32_bf16 v[108:111], v[36:39], v[132:135], v[108:111]
    v_cvt_pk_bf16_f32 v100, v100, v101
    v_cvt_pk_bf16_f32 v101, v102, v103
    s_waitcnt lgkmcnt(5)
    v_mfma_f32_16x16x32_bf16 v[112:115], v[40:43], v[120:123], 0
    v_mul_f32 v104, s69, v104
    v_mul_f32 v105, s69, v105
    v_mfma_f32_16x16x32_bf16 v[112:115], v[44:47], v[124:127], v[112:115]
    v_mul_f32 v106, s69, v106
    v_mfma_f32_16x16x16_bf16 v[108:111], v[76:77], v[136:137], v[108:111]
    v_mul_f32 v107, s69, v107
    v_mfma_f32_16x16x32_bf16 v[112:115], v[48:51], v[128:131], v[112:115]
    v_cvt_pk_bf16_f32 v102, v104, v105
    buffer_load_dwordx2 a[238:239], v228, s[28:31], s71 offen offset:128
    v_mfma_f32_16x16x32_bf16 v[112:115], v[52:55], v[132:135], v[112:115]
    v_cvt_pk_bf16_f32 v103, v106, v107
    s_waitcnt lgkmcnt(0)
    v_mfma_f32_16x16x32_bf16 v[116:119], v[56:59], v[120:123], 0
    v_mul_f32 v108, s69, v108
    v_mul_f32 v109, s69, v109
    v_mfma_f32_16x16x32_bf16 v[116:119], v[60:63], v[124:127], v[116:119]
    ds_write_b128 v186, v[100:103] offset:4096
    v_mul_f32 v110, s69, v110
    v_mfma_f32_16x16x16_bf16 v[112:115], v[78:79], v[136:137], v[112:115]
    v_mfma_f32_16x16x32_bf16 v[80:83], v[148:151], v[100:103], v[80:83]
    v_mul_f32 v111, s69, v111
    v_mfma_f32_16x16x32_bf16 v[116:119], v[64:67], v[128:131], v[116:119]
    v_cvt_pk_bf16_f32 v108, v108, v109
    buffer_load_dwordx2 a[240:241], v227, s[28:31], s70 offen
    v_mfma_f32_16x16x32_bf16 v[116:119], v[68:71], v[132:135], v[116:119]
    v_cvt_pk_bf16_f32 v109, v110, v111
    s_nop 5
    v_mfma_f32_16x16x16_bf16 v[116:119], v[72:73], v[136:137], v[116:119]
    v_mul_f32 v112, s69, v112
    v_mul_f32 v113, s69, v113
    v_mul_f32 v114, s69, v114
    v_mul_f32 v115, s69, v115
    v_cvt_pk_bf16_f32 v110, v112, v113
    v_cvt_pk_bf16_f32 v111, v114, v115
    s_nop 1
    v_mul_f32 v116, s69, v116
    v_mul_f32 v117, s69, v117
    ds_write_b128 v186, v[108:111] offset:6144
    v_mul_f32 v118, s69, v118
    v_mfma_f32_16x16x32_bf16 v[80:83], v[152:155], v[108:111], v[80:83]
    v_mul_f32 v119, s69, v119
    v_cvt_pk_bf16_f32 v116, v116, v117
    v_cvt_pk_bf16_f32 v117, v118, v119
    ds_write_b64 v187, v[116:117] offset:8192
    s_nop 1
    v_mfma_f32_16x16x16_bf16 v[80:83], v[156:157], v[116:117], v[80:83]
    s_nop 7
    v_max3_f32 v14, v80, v81, v82
    v_max_f32 v14, v14, v83
    v_mov_b32 v15, v14
    v_mov_b32 v16, v14
    s_nop 1
    v_permlane32_swap_b32 v15, v16
    v_max_f32 v14, v15, v16
    v_mov_b32 v15, v14
    v_mov_b32 v16, v14
    s_nop 1
    v_permlane16_swap_b32 v15, v16
    v_max_f32 v14, v15, v16
    v_sub_f32 v14, 0, v14
    ds_write_b32 v188, v14
    s_waitcnt vmcnt(6) lgkmcnt(0)
    s_barrier
    ds_read_b64_tr_b16 v[24:25], v22 offset:0
    ds_read_b64_tr_b16 v[26:27], v22 offset:4608
    ds_read_b64_tr_b16 v[28:29], v22 offset:9216
    ds_read_b64_tr_b16 v[30:31], v22 offset:13824
    ds_read_b64_tr_b16 v[32:33], v22 offset:18432
    ds_read_b64_tr_b16 v[34:35], v22 offset:23040
    ds_read_b64_tr_b16 v[36:37], v22 offset:27648
    ds_read_b64_tr_b16 v[38:39], v22 offset:32256
    ds_read_b64_tr_b16 v[72:73], v22 offset:36864
    ds_read_b64_tr_b16 v[40:41], v22 offset:32
    ds_read_b64_tr_b16 v[42:43], v22 offset:4640
    ds_read_b64_tr_b16 v[44:45], v22 offset:9248
    ds_read_b64_tr_b16 v[46:47], v22 offset:13856
    ds_read_b64_tr_b16 v[48:49], v22 offset:18464
    ds_read_b64_tr_b16 v[50:51], v22 offset:23072
    ds_read_b64_tr_b16 v[52:53], v22 offset:27680
    ds_read_b64_tr_b16 v[54:55], v22 offset:32288
    ds_read_b64_tr_b16 v[74:75], v22 offset:36896
    s_waitcnt lgkmcnt(9)
    v_mfma_f32_16x16x32_bf16 v[84:87], v[24:27], v[140:143], 0
    ds_read_b64_tr_b16 v[56:57], v22 offset:64
    ds_read_b64_tr_b16 v[58:59], v22 offset:4672
    ds_read_b64_tr_b16 v[60:61], v22 offset:9280
    v_mfma_f32_16x16x32_bf16 v[84:87], v[28:31], v[144:147], v[84:87]
    ds_read_b64_tr_b16 v[62:63], v22 offset:13888
    ds_read_b64_tr_b16 v[64:65], v22 offset:18496
    v_mfma_f32_16x16x32_bf16 v[84:87], v[32:35], v[148:151], v[84:87]
    ds_read_b64_tr_b16 v[66:67], v22 offset:23104
    ds_read_b64_tr_b16 v[68:69], v22 offset:27712
    v_mfma_f32_16x16x32_bf16 v[84:87], v[36:39], v[152:155], v[84:87]
    ds_read_b64_tr_b16 v[70:71], v22 offset:32320
    ds_read_b64_tr_b16 v[76:77], v22 offset:36928
    s_waitcnt lgkmcnt(9)
    v_mfma_f32_16x16x32_bf16 v[88:91], v[40:43], v[140:143], 0
    ds_read_b64_tr_b16 v[24:25], v22 offset:96
    ds_read_b64_tr_b16 v[26:27], v22 offset:4704
    v_mfma_f32_16x16x32_bf16 v[88:91], v[44:47], v[144:147], v[88:91]
    ds_read_b64_tr_b16 v[28:29], v22 offset:9312
    ds_read_b64_tr_b16 v[30:31], v22 offset:13920
    v_mfma_f32_16x16x16_bf16 v[84:87], v[72:73], v[156:157], v[84:87]
    ds_read_b64_tr_b16 v[32:33], v22 offset:18528
    ds_read_b64_tr_b16 v[34:35], v22 offset:23136
    v_mfma_f32_16x16x32_bf16 v[88:91], v[48:51], v[148:151], v[88:91]
    ds_read_b64_tr_b16 v[36:37], v22 offset:27744
    ds_read_b64_tr_b16 v[38:39], v22 offset:32352
    v_mfma_f32_16x16x32_bf16 v[88:91], v[52:55], v[152:155], v[88:91]
    ds_read_b64_tr_b16 v[78:79], v22 offset:36960
    s_waitcnt vmcnt(0)
    s_mov_b32 s68, 0
Lp_poll:
    v_cmp_eq_u32 vcc, s20, v210
    v_cmp_eq_u32 s[60:61], s20, v211
    s_nop 1
    s_and_b64 vcc, vcc, s[60:61]
    s_cmp_eq_u64 vcc, -1
    s_cbranch_scc1 Lp_ready
    s_sleep 1
    buffer_load_dwordx2 v[210:211], v215, s[4:7], s81 offen sc1
    s_waitcnt vmcnt(0)
    s_add_u32 s68, s68, 1
    s_cmp_lt_u32 s68, 200000
    s_cbranch_scc1 Lp_poll
Lp_ready:
    s_waitcnt lgkmcnt(9)
    v_mfma_f32_16x16x32_bf16 v[92:95], v[56:59], v[140:143], 0
    ds_read_b64_tr_b16 v[40:41], v22 offset:128
    ds_read_b64_tr_b16 v[42:43], v22 offset:4736
    ds_read_b64_tr_b16 v[44:45], v22 offset:9344
    v_mfma_f32_16x16x32_bf16 v[92:95], v[60:63], v[144:147], v[92:95]
    ds_read_b64_tr_b16 v[46:47], v22 offset:13952
    ds_read_b64_tr_b16 v[48:49], v22 offset:18560
    ds_read_b64_tr_b16 v[50:51], v22 offset:23168
    v_mfma_f32_16x16x16_bf16 v[88:91], v[74:75], v[156:157], v[88:91]
    ds_read_b64_tr_b16 v[52:53], v22 offset:27776
    ds_read_b64_tr_b16 v[54:55], v22 offset:32384
    v_mfma_f32_16x16x32_bf16 v[92:95], v[64:67], v[148:151], v[92:95]
    ds_read_b64_tr_b16 v[72:73], v22 offset:36992
    ds_read_b128 a[160:163], v189 offset:0
    s_add_u32 m0, s13, 0
    s_nop 0
    buffer_load_dwordx4 v206, s[4:7], s12 offen offset:0 sc1 lds
    buffer_load_dwordx4 v206, s[4:7], s12 offen offset:1024 sc1 lds
    buffer_load_dwordx4 v206, s[4:7], s12 offen offset:2048 sc1 lds
    v_mfma_f32_16x16x32_bf16 v[92:95], v[68:71], v[152:155], v[92:95]
    ds_read_b128 a[164:167], v189 offset:1024
    ds_read_b128 a[168:171], v189 offset:2048
    s_waitcnt lgkmcnt(9)
    v_mfma_f32_16x16x32_bf16 v[96:99], v[24:27], v[140:143], 0
    ds_read_b64_tr_b16 v[56:57], v22 offset:160
    ds_read_b64_tr_b16 v[58:59], v22 offset:4768
    ds_read_b64_tr_b16 v[60:61], v22 offset:9376
    v_mfma_f32_16x16x32_bf16 v[96:99], v[28:31], v[144:147], v[96:99]
    ds_read_b64_tr_b16 v[62:63], v22 offset:13984
    ds_read_b64_tr_b16 v[64:65], v22 offset:18592
    ds_read_b64_tr_b16 v[66:67], v22 offset:23200
    v_mfma_f32_16x16x16_bf16 v[92:95], v[76:77], v[156:157], v[92:95]
    ds_read_b64_tr_b16 v[68:69], v22 offset:27808
    ds_read_b64_tr_b16 v[70:71], v22 offset:32416
    v_mfma_f32_16x16x32_bf16 v[96:99], v[32:35], v[148:151], v[96:99]
    ds_read_b64_tr_b16 v[74:75], v22 offset:37024
    ds_read_b128 a[172:175], v189 offset:3072
    buffer_load_dwordx4 v206, s[4:7], s12 offen offset:3072 sc1 lds
    s_add_u32 m0, s13, 4096
    s_nop 0
    buffer_load_dwordx4 v207, s[4:7], s12 offen offset:0 sc1 lds
    buffer_load_dwordx4 v207, s[4:7], s12 offen offset:1024 sc1 lds
    v_mfma_f32_16x16x32_bf16 v[96:99], v[36:39], v[152:155], v[96:99]
    ds_read_b128 a[176:179], v189 offset:4096
    ds_read_b128 a[180:183], v189 offset:5120
    s_waitcnt lgkmcnt(9)
    v_mfma_f32_16x16x32_bf16 v[100:103], v[40:43], v[140:143], 0
    ds_read_b64_tr_b16 v[24:25], v22 offset:192
    ds_read_b64_tr_b16 v[26:27], v22 offset:4800
    ds_read_b64_tr_b16 v[28:29], v22 offset:9408
    v_mfma_f32_16x16x32_bf16 v[100:103], v[44:47], v[144:147], v[100:103]
    ds_read_b64_tr_b16 v[30:31], v22 offset:14016
    ds_read_b64_tr_b16 v[32:33], v22 offset:18624
    ds_read_b64_tr_b16 v[34:35], v22 offset:23232
    v_mfma_f32_16x16x16_bf16 v[96:99], v[78:79], v[156:157], v[96:99]
    ds_read_b64_tr_b16 v[36:37], v22 offset:27840
    ds_read_b64_tr_b16 v[38:39], v22 offset:32448
    v_mfma_f32_16x16x32_bf16 v[100:103], v[48:51], v[148:151], v[100:103]
    ds_read_b64_tr_b16 v[76:77], v22 offset:37056
    ds_read_b128 a[184:187], v189 offset:6144
    buffer_load_dwordx4 v207, s[4:7], s12 offen offset:2048 sc1 lds
    buffer_load_dwordx4 v207, s[4:7], s12 offen offset:3072 sc1 lds
    s_add_u32 m0, s13, 8192
    s_nop 0
    buffer_load_dwordx4 v208, s[4:7], s12 offen offset:0 sc1 lds
    s_add_u32 s12, s12, s15
    v_mfma_f32_16x16x32_bf16 v[100:103], v[52:55], v[152:155], v[100:103]
    ds_read_b128 a[188:191], v189 offset:7168
    ds_read_b128 a[192:195], v189 offset:8192
    s_waitcnt lgkmcnt(9)
    v_mfma_f32_16x16x32_bf16 v[104:107], v[56:59], v[140:143], 0
    ds_read_b64_tr_b16 v[40:41], v22 offset:224
    ds_read_b64_tr_b16 v[42:43], v22 offset:4832
    ds_read_b64_tr_b16 v[44:45], v22 offset:9440
    v_mfma_f32_16x16x32_bf16 v[104:107], v[60:63], v[144:147], v[104:107]
    ds_read_b64_tr_b16 v[46:47], v22 offset:14048
    ds_read_b64_tr_b16 v[48:49], v22 offset:18656
    ds_read_b64_tr_b16 v[50:51], v22 offset:23264
    v_mfma_f32_16x16x16_bf16 v[100:103], v[72:73], v[156:157], v[100:103]
    ds_read_b64_tr_b16 v[52:53], v22 offset:27872
    ds_read_b64_tr_b16 v[54:55], v22 offset:32480
    v_mfma_f32_16x16x32_bf16 v[104:107], v[64:67], v[148:151], v[104:107]
    ds_read_b64_tr_b16 v[78:79], v22 offset:37088
    ds_read_b128 a[196:199], v209 offset:0
    s_add_u32 m0, s13, 36864
    s_nop 0
    buffer_load_dwordx4 v206, s[4:7], s12 offen offset:0 sc1 lds
    buffer_load_dwordx4 v206, s[4:7], s12 offen offset:1024 sc1 lds
    buffer_load_dwordx4 v206, s[4:7], s12 offen offset:2048 sc1 lds
    v_mfma_f32_16x16x32_bf16 v[104:107], v[68:71], v[152:155], v[104:107]
    ds_read_b128 a[200:203], v209 offset:1024
    ds_read_b128 a[204:207], v209 offset:2048
    s_waitcnt lgkmcnt(9)
    v_mfma_f32_16x16x32_bf16 v[108:111], v[24:27], v[140:143], 0
    ds_read_b64_tr_b16 v[56:57], v22 offset:256
    ds_read_b64_tr_b16 v[58:59], v22 offset:4864
    ds_read_b64_tr_b16 v[60:61], v22 offset:9472
    v_mfma_f32_16x16x32_bf16 v[108:111], v[28:31], v[144:147], v[108:111]
    ds_read_b64_tr_b16 v[62:63], v22 offset:14080
    ds_read_b64_tr_b16 v[64:65], v22 offset:18688
    ds_read_b64_tr_b16 v[66:67], v22 offset:23296
    v_mfma_f32_16x16x16_bf16 v[104:107], v[74:75], v[156:157], v[104:107]
    ds_read_b64_tr_b16 v[68:69], v22 offset:27904
    ds_read_b64_tr_b16 v[70:71], v22 offset:32512
    v_mfma_f32_16x16x32_bf16 v[108:111], v[32:35], v[148:151], v[108:111]
    ds_read_b64_tr_b16 v[72:73], v22 offset:37120
    ds_read_b128 a[208:211], v209 offset:3072
    buffer_load_dwordx4 v206, s[4:7], s12 offen offset:3072 sc1 lds
    s_add_u32 m0, s13, 40960
    s_nop 0
    buffer_load_dwordx4 v207, s[4:7], s12 offen offset:0 sc1 lds
    v_mfma_f32_16x16x32_bf16 v[108:111], v[36:39], v[152:155], v[108:111]
    ds_read_b128 a[212:215], v209 offset:4096
    ds_read_b128 a[216:219], v209 offset:5120
    s_waitcnt lgkmcnt(9)
    v_mfma_f32_16x16x32_bf16 v[112:115], v[40:43], v[140:143], 0
    ds_read_b128 a[220:223], v209 offset:6144
    v_mfma_f32_16x16x32_bf16 v[112:115], v[44:47], v[144:147], v[112:115]
    ds_read_b128 a[224:227], v209 offset:7168
    v_mfma_f32_16x16x16_bf16 v[108:111], v[76:77], v[156:157], v[108:111]
    ds_read_b128 a[228:231], v209 offset:8192
    v_mfma_f32_16x16x32_bf16 v[112:115], v[48:51], v[148:151], v[112:115]
    buffer_load_dwordx4 v207, s[4:7], s12 offen offset:1024 sc1 lds
    buffer_load_dwordx4 v207, s[4:7], s12 offen offset:2048 sc1 lds
    v_mfma_f32_16x16x32_bf16 v[112:115], v[52:55], v[152:155], v[112:115]
    s_waitcnt lgkmcnt(0)
    v_mfma_f32_16x16x32_bf16 v[116:119], v[56:59], v[140:143], 0
    ds_read_b32 v218, v212
    v_mfma_f32_16x16x32_bf16 v[116:119], v[60:63], v[144:147], v[116:119]
    ds_read_b32 v219, v213
    s_nop 0
    v_mfma_f32_16x16x16_bf16 v[112:115], v[78:79], v[156:157], v[112:115]
    v_mfma_f32_16x16x32_bf16 v[116:119], v[64:67], v[148:151], v[116:119]
    buffer_load_dwordx4 v207, s[4:7], s12 offen offset:3072 sc1 lds
    s_add_u32 m0, s13, 45056
    s_nop 0
    buffer_load_dwordx4 v208, s[4:7], s12 offen offset:0 sc1 lds
    s_add_u32 s12, s12, 9216
    v_mfma_f32_16x16x32_bf16 v[116:119], v[68:71], v[152:155], v[116:119]
    s_nop 5
    v_mfma_f32_16x16x16_bf16 v[116:119], v[72:73], v[156:157], v[116:119]
    s_waitcnt lgkmcnt(0)
    s_barrier
    s_mov_b32 s28, s48
    s_mov_b32 s29, s49
    s_mov_b32 s30, 4320
    s_mov_b32 s31, 0x00020000
    s_mov_b32 exec_hi, 0
    v_cvt_pk_bf16_f32 v234, v218, 0
    v_cvt_pk_bf16_f32 v238, v219, 0
    s_mov_b64 exec, -1
    v_mov_b32 v158, 0xc0135761
    v_mov_b32 v159, 0xc0135761
    v_mov_b32 v160, 0xbdd2d3e8
    v_mov_b32 v161, 0xbdd2d3e8
    v_mov_b32 v162, 1.0
    v_mov_b32 v163, 1.0
    v_pk_mul_f32 v[8:9], v[84:85], v[84:85]
    v_pk_mul_f32 v[10:11], v[86:87], v[86:87]
    v_pk_mul_f32 v[12:13], v[88:89], v[88:89]
    s_add_u32 m0, s13, 73728
    s_nop 0
    buffer_load_dwordx4 v206, s[4:7], s12 offen offset:0 sc1 lds
    v_pk_fma_f32 v[8:9], v[8:9], v[160:161], v[158:159]
    v_pk_fma_f32 v[10:11], v[10:11], v[160:161], v[158:159]
    v_pk_fma_f32 v[12:13], v[12:13], v[160:161], v[158:159]
    v_pk_mul_f32 v[8:9], v[8:9], v[84:85]
    v_pk_mul_f32 v[10:11], v[10:11], v[86:87]
    v_pk_mul_f32 v[12:13], v[12:13], v[88:89]
    v_exp_f32 v8, v8
    v_exp_f32 v9, v9
    v_exp_f32 v10, v10
    v_exp_f32 v11, v11
    v_exp_f32 v12, v12
    v_exp_f32 v13, v13
    v_pk_add_f32 v[8:9], v[8:9], v[162:163]
    v_pk_add_f32 v[10:11], v[10:11], v[162:163]
    buffer_load_dwordx4 v206, s[4:7], s12 offen offset:1024 sc1 lds
    v_pk_add_f32 v[12:13], v[12:13], v[162:163]
    v_rcp_f32 v8, v8
    v_rcp_f32 v9, v9
    v_rcp_f32 v10, v10
    v_rcp_f32 v11, v11
    v_rcp_f32 v12, v12
    v_rcp_f32 v13, v13
    v_pk_mul_f32 v[84:85], v[84:85], v[8:9]
    v_pk_mul_f32 v[86:87], v[86:87], v[10:11]
    v_pk_mul_f32 v[88:89], v[88:89], v[12:13]
    v_pk_mul_f32 v[8:9], v[90:91], v[90:91]
    v_pk_mul_f32 v[10:11], v[92:93], v[92:93]
    v_pk_mul_f32 v[12:13], v[94:95], v[94:95]
    v_pk_fma_f32 v[8:9], v[8:9], v[160:161], v[158:159]
    buffer_load_dwordx4 v206, s[4:7], s12 offen offset:2048 sc1 lds
    v_pk_fma_f32 v[10:11], v[10:11], v[160:161], v[158:159]
    v_pk_fma_f32 v[12:13], v[12:13], v[160:161], v[158:159]
    v_pk_mul_f32 v[8:9], v[8:9], v[90:91]
    v_pk_mul_f32 v[10:11], v[10:11], v[92:93]
    v_pk_mul_f32 v[12:13], v[12:13], v[94:95]
    v_exp_f32 v8, v8
    v_exp_f32 v9, v9
    v_exp_f32 v10, v10
    v_exp_f32 v11, v11
    v_exp_f32 v12, v12
    v_exp_f32 v13, v13
    v_pk_add_f32 v[8:9], v[8:9], v[162:163]
    v_pk_add_f32 v[10:11], v[10:11], v[162:163]
    v_pk_add_f32 v[12:13], v[12:13], v[162:163]
    buffer_load_dwordx4 v206, s[4:7], s12 offen offset:3072 sc1 lds
    v_rcp_f32 v8, v8
    v_rcp_f32 v9, v9
    v_rcp_f32 v10, v10
    v_rcp_f32 v11, v11
    v_rcp_f32 v12, v12
    v_rcp_f32 v13, v13
    v_pk_mul_f32 v[90:91], v[90:91], v[8:9]
    v_pk_mul_f32 v[92:93], v[92:93], v[10:11]
    v_pk_mul_f32 v[94:95], v[94:95], v[12:13]
    v_pk_mul_f32 v[8:9], v[96:97], v[96:97]
    v_pk_mul_f32 v[10:11], v[98:99], v[98:99]
    v_pk_mul_f32 v[12:13], v[100:101], v[100:101]
    v_pk_fma_f32 v[8:9], v[8:9], v[160:161], v[158:159]
    v_pk_fma_f32 v[10:11], v[10:11], v[160:161], v[158:159]
    s_add_u32 m0, s13, 77824
    s_nop 0
    buffer_load_dwordx4 v207, s[4:7], s12 offen offset:0 sc1 lds
    v_pk_fma_f32 v[12:13], v[12:13], v[160:161], v[158:159]
    v_pk_mul_f32 v[8:9], v[8:9], v[96:97]
    v_pk_mul_f32 v[10:11], v[10:11], v[98:99]
    v_pk_mul_f32 v[12:13], v[12:13], v[100:101]
    v_exp_f32 v8, v8
    v_exp_f32 v9, v9
    v_exp_f32 v10, v10
    v_exp_f32 v11, v11
    v_exp_f32 v12, v12
    v_exp_f32 v13, v13
    v_pk_add_f32 v[8:9], v[8:9], v[162:163]
    v_pk_add_f32 v[10:11], v[10:11], v[162:163]
    v_pk_add_f32 v[12:13], v[12:13], v[162:163]
    v_rcp_f32 v8, v8
    buffer_load_dwordx4 v207, s[4:7], s12 offen offset:1024 sc1 lds
    v_rcp_f32 v9, v9
    v_rcp_f32 v10, v10
    v_rcp_f32 v11, v11
    v_rcp_f32 v12, v12
    v_rcp_f32 v13, v13
    v_pk_mul_f32 v[96:97], v[96:97], v[8:9]
    v_pk_mul_f32 v[98:99], v[98:99], v[10:11]
    v_pk_mul_f32 v[100:101], v[100:101], v[12:13]
    v_pk_mul_f32 v[8:9], v[102:103], v[102:103]
    v_pk_mul_f32 v[10:11], v[104:105], v[104:105]
    v_pk_mul_f32 v[12:13], v[106:107], v[106:107]
    v_pk_fma_f32 v[8:9], v[8:9], v[160:161], v[158:159]
    v_pk_fma_f32 v[10:11], v[10:11], v[160:161], v[158:159]
    v_pk_fma_f32 v[12:13], v[12:13], v[160:161], v[158:159]
    buffer_load_dwordx4 v207, s[4:7], s12 offen offset:2048 sc1 lds
    v_pk_mul_f32 v[8:9], v[8:9], v[102:103]
    v_pk_mul_f32 v[10:11], v[10:11], v[104:105]
    v_pk_mul_f32 v[12:13], v[12:13], v[106:107]
    v_exp_f32 v8, v8
    v_exp_f32 v9, v9
    v_exp_f32 v10, v10
    v_exp_f32 v11, v11
    v_exp_f32 v12, v12
    v_exp_f32 v13, v13
    v_pk_add_f32 v[8:9], v[8:9], v[162:163]
    v_pk_add_f32 v[10:11], v[10:11], v[162:163]
    v_pk_add_f32 v[12:13], v[12:13], v[162:163]
    v_rcp_f32 v8, v8
    v_rcp_f32 v9, v9
    buffer_load_dwordx4 v207, s[4:7], s12 offen offset:3072 sc1 lds
    v_rcp_f32 v10, v10
    v_rcp_f32 v11, v11
    v_rcp_f32 v12, v12
    v_rcp_f32 v13, v13
    v_pk_mul_f32 v[102:103], v[102:103], v[8:9]
    v_pk_mul_f32 v[104:105], v[104:105], v[10:11]
    v_pk_mul_f32 v[106:107], v[106:107], v[12:13]
    v_pk_mul_f32 v[8:9], v[108:109], v[108:109]
    v_pk_mul_f32 v[10:11], v[110:111], v[110:111]
    v_pk_mul_f32 v[12:13], v[112:113], v[112:113]
    v_pk_fma_f32 v[8:9], v[8:9], v[160:161], v[158:159]
    v_pk_fma_f32 v[10:11], v[10:11], v[160:161], v[158:159]
    v_pk_fma_f32 v[12:13], v[12:13], v[160:161], v[158:159]
    v_pk_mul_f32 v[8:9], v[8:9], v[108:109]
    s_add_u32 m0, s13, 81920
    s_nop 0
    buffer_load_dwordx4 v208, s[4:7], s12 offen offset:0 sc1 lds
    s_add_u32 s12, s12, 9216
    v_pk_mul_f32 v[10:11], v[10:11], v[110:111]
    v_pk_mul_f32 v[12:13], v[12:13], v[112:113]
    v_exp_f32 v8, v8
    v_exp_f32 v9, v9
    v_exp_f32 v10, v10
    v_exp_f32 v11, v11
    v_exp_f32 v12, v12
    v_exp_f32 v13, v13
    v_pk_add_f32 v[8:9], v[8:9], v[162:163]
    v_pk_add_f32 v[10:11], v[10:11], v[162:163]
    v_pk_add_f32 v[12:13], v[12:13], v[162:163]
    v_rcp_f32 v8, v8
    v_rcp_f32 v9, v9
    v_rcp_f32 v10, v10
    s_lshl_b32 s64, s16, 10
    s_add_u32 m0, s64, 151552
    s_nop 0
    buffer_load_dwordx4 v7, s[28:31], s64 offen lds
    v_rcp_f32 v11, v11
    v_rcp_f32 v12, v12
    v_rcp_f32 v13, v13
    v_pk_mul_f32 v[108:109], v[108:109], v[8:9]
    v_pk_mul_f32 v[110:111], v[110:111], v[10:11]
    v_pk_mul_f32 v[112:113], v[112:113], v[12:13]
    v_pk_mul_f32 v[8:9], v[114:115], v[114:115]
    v_pk_mul_f32 v[10:11], v[116:117], v[116:117]
    v_pk_mul_f32 v[12:13], v[118:119], v[118:119]
    v_pk_fma_f32 v[8:9], v[8:9], v[160:161], v[158:159]
    v_pk_fma_f32 v[10:11], v[10:11], v[160:161], v[158:159]
    v_pk_fma_f32 v[12:13], v[12:13], v[160:161], v[158:159]
    v_pk_mul_f32 v[8:9], v[8:9], v[114:115]
    v_pk_mul_f32 v[10:11], v[10:11], v[116:117]
    s_mov_b32 s64, 4096
    s_mov_b32 m0, 155648
    s_nop 0
    buffer_load_dwordx4 v7, s[28:31], s64 offen lds
    v_pk_mul_f32 v[12:13], v[12:13], v[118:119]
    v_exp_f32 v8, v8
    v_exp_f32 v9, v9
    v_exp_f32 v10, v10
    v_exp_f32 v11, v11
    v_exp_f32 v12, v12
    v_exp_f32 v13, v13
    v_pk_add_f32 v[8:9], v[8:9], v[162:163]
    v_pk_add_f32 v[10:11], v[10:11], v[162:163]
    v_pk_add_f32 v[12:13], v[12:13], v[162:163]
    v_rcp_f32 v8, v8
    v_rcp_f32 v9, v9
    v_rcp_f32 v10, v10
    v_rcp_f32 v11, v11
    v_rcp_f32 v12, v12
    v_rcp_f32 v13, v13
    v_pk_mul_f32 v[114:115], v[114:115], v[8:9]
    v_pk_mul_f32 v[116:117], v[116:117], v[10:11]
    v_pk_mul_f32 v[118:119], v[118:119], v[12:13]
    s_cmp_eq_u32 s19, 1
    s_cbranch_scc1 Lp_gln
    v_cvt_pk_bf16_f32 v120, v84, v85
    v_cvt_pk_bf16_f32 v121, v86, v87
    v_cvt_pk_bf16_f32 v122, v88, v89
    v_cvt_pk_bf16_f32 v123, v90, v91
    v_cvt_pk_bf16_f32 v124, v92, v93
    v_cvt_pk_bf16_f32 v125, v94, v95
    v_cvt_pk_bf16_f32 v126, v96, v97
    v_cvt_pk_bf16_f32 v127, v98, v99
    v_cvt_pk_bf16_f32 v128, v100, v101
    v_cvt_pk_bf16_f32 v129, v102, v103
    v_cvt_pk_bf16_f32 v130, v104, v105
    v_cvt_pk_bf16_f32 v131, v106, v107
    v_cvt_pk_bf16_f32 v132, v108, v109
    v_cvt_pk_bf16_f32 v133, v110, v111
    v_cvt_pk_bf16_f32 v134, v112, v113
    v_cvt_pk_bf16_f32 v135, v114, v115
    v_cvt_pk_bf16_f32 v136, v116, v117
    v_cvt_pk_bf16_f32 v137, v118, v119
    s_branch Lp_ugst
Lp_gln:
    v_pk_add_f32 v[8:9], v[84:85], v[86:87]
    v_pk_mul_f32 v[10:11], v[84:85], v[84:85]
    v_pk_mul_f32 v[12:13], v[86:87], v[86:87]
    v_pk_add_f32 v[8:9], v[8:9], v[88:89]
    v_pk_fma_f32 v[10:11], v[88:89], v[88:89], v[10:11]
    v_pk_add_f32 v[8:9], v[8:9], v[90:91]
    v_pk_fma_f32 v[12:13], v[90:91], v[90:91], v[12:13]
    v_pk_add_f32 v[8:9], v[8:9], v[92:93]
    v_pk_fma_f32 v[10:11], v[92:93], v[92:93], v[10:11]
    v_pk_add_f32 v[8:9], v[8:9], v[94:95]
    v_pk_fma_f32 v[12:13], v[94:95], v[94:95], v[12:13]
    v_pk_add_f32 v[8:9], v[8:9], v[96:97]
    v_pk_fma_f32 v[10:11], v[96:97], v[96:97], v[10:11]
    v_pk_add_f32 v[8:9], v[8:9], v[98:99]
    v_pk_fma_f32 v[12:13], v[98:99], v[98:99], v[12:13]
    v_pk_add_f32 v[8:9], v[8:9], v[100:101]
    v_pk_fma_f32 v[10:11], v[100:101], v[100:101], v[10:11]
    v_pk_add_f32 v[8:9], v[8:9], v[102:103]
    v_pk_fma_f32 v[12:13], v[102:103], v[102:103], v[12:13]
    v_pk_add_f32 v[8:9], v[8:9], v[104:105]
    v_pk_fma_f32 v[10:11], v[104:105], v[104:105], v[10:11]
    v_pk_add_f32 v[8:9], v[8:9], v[106:107]
    v_pk_fma_f32 v[12:13], v[106:107], v[106:107], v[12:13]
    v_pk_add_f32 v[8:9], v[8:9], v[108:109]
    v_pk_fma_f32 v[10:11], v[108:109], v[108:109], v[10:11]
    v_pk_add_f32 v[8:9], v[8:9], v[110:111]
    v_pk_fma_f32 v[12:13], v[110:111], v[110:111], v[12:13]
    v_pk_add_f32 v[8:9], v[8:9], v[112:113]
    v_pk_fma_f32 v[10:11], v[112:113], v[112:113], v[10:11]
    v_pk_add_f32 v[8:9], v[8:9], v[114:115]
    v_pk_fma_f32 v[12:13], v[114:115], v[114:115], v[12:13]
    v_pk_add_f32 v[8:9], v[8:9], v[116:117]
    v_pk_fma_f32 v[10:11], v[116:117], v[116:117], v[10:11]
    v_pk_add_f32 v[8:9], v[8:9], v[118:119]
    v_pk_fma_f32 v[12:13], v[118:119], v[118:119], v[12:13]
    v_pk_add_f32 v[10:11], v[10:11], v[12:13]
    v_add_f32 v8, v8, v9
    v_add_f32 v10, v10, v11
    s_nop 1
    v_permlane32_swap_b32 v8, v10
    v_add_f32 v8, v8, v10
    v_mov_b32 v10, v8
    s_nop 1
    v_permlane16_swap_b32 v8, v10
    v_add_f32 v8, v8, v10
    v_mov_b32 v10, v8
    s_nop 1
    v_permlane32_swap_b32 v8, v10
    v_mul_f32 v8, 0x3be38e39, v8
    v_mul_f32 v10, 0x3be38e39, v10
    v_fma_f32 v10, -v8, v8, v10
    v_max_f32 v10, 0, v10
    v_add_f32 v10, 0x3727c5ac, v10
    v_rsq_f32 v16, v10
    s_nop 0
    v_mul_f32 v18, v8, v16
    v_mov_b32 v17, v16
    v_sub_f32 v18, 0, v18
    v_mov_b32 v19, v18
    v_pk_fma_f32 v[84:85], v[84:85], v[16:17], v[18:19]
    v_pk_fma_f32 v[86:87], v[86:87], v[16:17], v[18:19]
    v_cvt_pk_bf16_f32 v120, v84, v85
    v_pk_fma_f32 v[88:89], v[88:89], v[16:17], v[18:19]
    v_cvt_pk_bf16_f32 v121, v86, v87
    v_pk_fma_f32 v[90:91], v[90:91], v[16:17], v[18:19]
    v_cvt_pk_bf16_f32 v122, v88, v89
    v_pk_fma_f32 v[92:93], v[92:93], v[16:17], v[18:19]
    v_cvt_pk_bf16_f32 v123, v90, v91
    v_pk_fma_f32 v[94:95], v[94:95], v[16:17], v[18:19]
    v_cvt_pk_bf16_f32 v124, v92, v93
    v_pk_fma_f32 v[96:97], v[96:97], v[16:17], v[18:19]
    v_cvt_pk_bf16_f32 v125, v94, v95
    v_pk_fma_f32 v[98:99], v[98:99], v[16:17], v[18:19]
    v_cvt_pk_bf16_f32 v126, v96, v97
    v_pk_fma_f32 v[100:101], v[100:101], v[16:17], v[18:19]
    v_cvt_pk_bf16_f32 v127, v98, v99
    v_pk_fma_f32 v[102:103], v[102:103], v[16:17], v[18:19]
    v_cvt_pk_bf16_f32 v128, v100, v101
    v_pk_fma_f32 v[104:105], v[104:105], v[16:17], v[18:19]
    v_cvt_pk_bf16_f32 v129, v102, v103
    v_pk_fma_f32 v[106:107], v[106:107], v[16:17], v[18:19]
    v_cvt_pk_bf16_f32 v130, v104, v105
    v_pk_fma_f32 v[108:109], v[108:109], v[16:17], v[18:19]
    v_cvt_pk_bf16_f32 v131, v106, v107
    v_pk_fma_f32 v[110:111], v[110:111], v[16:17], v[18:19]
    v_cvt_pk_bf16_f32 v132, v108, v109
    v_pk_fma_f32 v[112:113], v[112:113], v[16:17], v[18:19]
    v_cvt_pk_bf16_f32 v133, v110, v111
    v_pk_fma_f32 v[114:115], v[114:115], v[16:17], v[18:19]
    v_cvt_pk_bf16_f32 v134, v112, v113
    v_pk_fma_f32 v[116:117], v[116:117], v[16:17], v[18:19]
    v_cvt_pk_bf16_f32 v135, v114, v115
    v_pk_fma_f32 v[118:119], v[118:119], v[16:17], v[18:19]
    v_cvt_pk_bf16_f32 v136, v116, v117
    v_cvt_pk_bf16_f32 v137, v118, v119
    s_cmp_eq_u32 s16, 0
    s_cbranch_scc0 Lp_ugst
    s_cmp_eq_u32 s18, 0
    s_cselect_b32 s60, 1, 0
    s_cmp_eq_u32 s18, 62
    s_cselect_b32 s61, 1, 0
    s_or_b32 s60, s60, s61
    s_cmp_eq_u32 s60, 0
    s_cbranch_scc1 Lp_ugst
    s_mul_i32 s61, s61, 4008
    s_mul_i32 s60, s17, 4016
    s_add_u32 s60, s60, s61
    s_mul_i32 s60, s60, 288
    s_add_u32 s60, s60, 7864320
    buffer_store_dwordx4 v[242:245], v7, s[4:7], s60 offen sc1
    buffer_store_dwordx4 v[242:245], v7, s[4:7], s60 offen offset:1024 sc1
    s_mov_b64 exec, 0xffff
    buffer_store_dwordx4 v[242:245], v7, s[4:7], s60 offen offset:2048 sc1
    s_mov_b64 exec, -1
    s_waitcnt vmcnt(0)
Lp_ugst:
    v_mfma_f32_32x32x16_bf16 v[64:79], v[230:233], v[234:237], 0
    v_mfma_f32_32x32x16_bf16 v[80:95], v[230:233], v[238:241], 0
    ds_write_b64 v246, v[120:121] offset:0
    ds_write_b64 v246, v[122:123] offset:32
    ds_write_b64 v246, v[124:125] offset:64
    ds_write_b64 v246, v[126:127] offset:96
    ds_write_b64 v246, v[128:129] offset:128
    ds_write_b64 v246, v[130:131] offset:160
    ds_write_b64 v246, v[132:133] offset:192
    ds_write_b64 v246, v[134:135] offset:224
    ds_write_b64 v246, v[136:137] offset:256
    s_add_u32 s61, s75, 4096
    s_waitcnt lgkmcnt(0)
    ds_read_b128 v[96:99], v247 offset:0
    ds_read_b128 v[100:103], v248 offset:1024
    ds_read_b128 v[104:107], v249 offset:2048
    ds_read_b128 v[108:111], v250 offset:3072
    ds_read_b128 v[124:127], v251 offset:4096
    v_mov_b32 v160, 0
    v_mov_b32 v161, 0
    v_mov_b32 v162, 0
    v_mov_b32 v163, 0
    s_mov_b32 s24, s4
    s_mov_b32 s25, s5
    s_mov_b32 s26, 0
    s_mov_b32 s27, 0x00020000
    s_mov_b32 s28, s4
    s_mov_b32 s29, s5
    s_mov_b32 s30, 0x10000000
    s_mov_b32 s31, 0x00020000
    v_mov_b32 v246, v7
    s_cmp_eq_u32 s72, 1
    s_cbranch_scc1 Lp_dum
    s_waitcnt vmcnt(20)
    ds_read_b128 v[112:115], v190 offset:0
    ds_read_b128 v[116:119], v191 offset:1024
    ds_read_b128 v[120:123], v190 offset:2048
    s_waitcnt lgkmcnt(2)
    v_mfma_f32_32x32x16_bf16 v[0:15], v[112:115], a[160:163], v[64:79]
    v_mfma_f32_32x32x16_bf16 v[16:31], v[112:115], a[196:199], v[80:95]
    ds_read_b128 v[112:115], v191 offset:3072
    buffer_store_dwordx4 v[96:99], v246, s[4:7], s75 offen offset:0 sc1
    s_waitcnt lgkmcnt(2)
    v_mfma_f32_32x32x16_bf16 v[0:15], v[116:119], a[164:167], v[0:15]
    v_mfma_f32_32x32x16_bf16 v[16:31], v[116:119], a[200:203], v[16:31]
    ds_read_b128 v[116:119], v190 offset:4096
    s_waitcnt lgkmcnt(2)
    v_mfma_f32_32x32x16_bf16 v[0:15], v[120:123], a[168:171], v[0:15]
    v_mfma_f32_32x32x16_bf16 v[16:31], v[120:123], a[204:207], v[16:31]
    ds_read_b128 v[120:123], v191 offset:5120
    buffer_store_dwordx4 v[100:103], v246, s[4:7], s75 offen offset:1024 sc1
    s_waitcnt lgkmcnt(2)
    v_mfma_f32_32x32x16_bf16 v[0:15], v[112:115], a[172:175], v[0:15]
    v_mfma_f32_32x32x16_bf16 v[16:31], v[112:115], a[208:211], v[16:31]
    ds_read_b128 v[112:115], v190 offset:6144
    s_waitcnt lgkmcnt(2)
    v_mfma_f32_32x32x16_bf16 v[0:15], v[116:119], a[176:179], v[0:15]
    v_mfma_f32_32x32x16_bf16 v[16:31], v[116:119], a[212:215], v[16:31]
    ds_read_b128 v[116:119], v191 offset:7168
    buffer_store_dwordx4 v[104:107], v246, s[4:7], s75 offen offset:2048 sc1
    s_waitcnt lgkmcnt(2)
    v_mfma_f32_32x32x16_bf16 v[0:15], v[120:123], a[180:183], v[0:15]
    v_mfma_f32_32x32x16_bf16 v[16:31], v[120:123], a[216:219], v[16:31]
    ds_read_b128 v[120:123], v190 offset:8192
    s_waitcnt lgkmcnt(2)
    v_mfma_f32_32x32x16_bf16 v[0:15], v[112:115], a[184:187], v[0:15]
    v_mfma_f32_32x32x16_bf16 v[16:31], v[112:115], a[220:223], v[16:31]
    buffer_store_dwordx4 v[108:111], v246, s[4:7], s75 offen offset:3072 sc1
    s_waitcnt lgkmcnt(1)
    v_mfma_f32_32x32x16_bf16 v[0:15], v[116:119], a[188:191], v[0:15]
    v_mfma_f32_32x32x16_bf16 v[16:31], v[116:119], a[224:227], v[16:31]
    s_waitcnt lgkmcnt(0)
    v_mfma_f32_32x32x16_bf16 v[0:15], v[120:123], a[192:195], v[0:15]
    v_mfma_f32_32x32x16_bf16 v[16:31], v[120:123], a[228:231], v[16:31]
    s_mov_b32 exec_hi, 0
    buffer_store_dwordx4 v[124:127], v246, s[4:7], s61 offen sc1
    s_mov_b64 exec, -1
    s_waitcnt vmcnt(16)
    ds_read_b64_tr_b16 v[124:125], v194 offset:0
    ds_read_b64_tr_b16 v[126:127], v194 offset:256
    ds_read_b64_tr_b16 v[128:129], v195 offset:1024
    ds_read_b64_tr_b16 v[130:131], v195 offset:1280
    ds_read_b64_tr_b16 v[132:133], v194 offset:2048
    ds_read_b64_tr_b16 v[134:135], v194 offset:2304
    ds_read_b64_tr_b16 v[136:137], v195 offset:3072
    ds_read_b128 v[112:115], v190 offset:36864
    ds_read_b64_tr_b16 v[138:139], v195 offset:3328
    ds_read_b64_tr_b16 v[140:141], v194 offset:4096
    ds_read_b128 v[116:119], v191 offset:37888
    ds_read_b64_tr_b16 v[142:143], v194 offset:4352
    ds_read_b64_tr_b16 v[144:145], v195 offset:5120
    ds_read_b128 v[120:123], v190 offset:38912
    ds_read_b64_tr_b16 v[146:147], v195 offset:5376
    ds_read_b64_tr_b16 v[148:149], v194 offset:6144
    ds_read_b64_tr_b16 v[150:151], v194 offset:6400
    ds_read_b64_tr_b16 v[152:153], v195 offset:7168
    ds_read_b64_tr_b16 v[154:155], v195 offset:7424
    s_branch Lk_loop
Lp_dum:
    s_waitcnt lgkmcnt(0)
    buffer_store_dwordx4 v[96:99], v246, s[4:7], s75 offen offset:0 sc1
    buffer_store_dwordx4 v[100:103], v246, s[4:7], s75 offen offset:1024 sc1
    buffer_store_dwordx4 v[104:107], v246, s[4:7], s75 offen offset:2048 sc1
    buffer_store_dwordx4 v[108:111], v246, s[4:7], s75 offen offset:3072 sc1
    s_mov_b32 exec_hi, 0
    buffer_store_dwordx4 v[124:127], v246, s[4:7], s61 offen sc1
    s_mov_b64 exec, -1
    s_waitcnt vmcnt(16)
    ds_read_b128 v[112:115], v190 offset:36864
    ds_read_b128 v[116:119], v191 offset:37888
    ds_read_b128 v[120:123], v190 offset:38912
    s_waitcnt lgkmcnt(0)
    s_waitcnt lgkmcnt(11)
    v_mfma_f32_32x32x16_bf16 v[32:47], v[112:115], a[160:163], v[64:79]
    v_mfma_f32_32x32x16_bf16 v[48:63], v[112:115], a[196:199], v[80:95]
    ds_read_b128 v[112:115], v191 offset:39936
    s_waitcnt lgkmcnt(9)
    v_mfma_f32_32x32x16_bf16 v[32:47], v[116:119], a[164:167], v[32:47]
    v_mfma_f32_32x32x16_bf16 v[48:63], v[116:119], a[200:203], v[48:63]
    ds_read_b128 v[116:119], v190 offset:40960
    s_waitcnt lgkmcnt(7)
    v_mfma_f32_32x32x16_bf16 v[32:47], v[120:123], a[168:171], v[32:47]
    v_mfma_f32_32x32x16_bf16 v[48:63], v[120:123], a[204:207], v[48:63]
    ds_read_b128 v[120:123], v191 offset:41984
    s_waitcnt lgkmcnt(2)
    v_mfma_f32_32x32x16_bf16 v[32:47], v[112:115], a[172:175], v[32:47]
    v_mfma_f32_32x32x16_bf16 v[48:63], v[112:115], a[208:211], v[48:63]
    ds_read_b128 v[112:115], v190 offset:43008
    s_waitcnt lgkmcnt(2)
    v_mfma_f32_32x32x16_bf16 v[32:47], v[116:119], a[176:179], v[32:47]
    v_mfma_f32_32x32x16_bf16 v[48:63], v[116:119], a[212:215], v[48:63]
    ds_read_b128 v[116:119], v191 offset:44032
    s_waitcnt lgkmcnt(2)
    v_mfma_f32_32x32x16_bf16 v[32:47], v[120:123], a[180:183], v[32:47]
    v_mfma_f32_32x32x16_bf16 v[48:63], v[120:123], a[216:219], v[48:63]
    ds_read_b128 v[120:123], v190 offset:45056
    s_waitcnt lgkmcnt(2)
    v_mfma_f32_32x32x16_bf16 v[32:47], v[112:115], a[184:187], v[32:47]
    v_mfma_f32_32x32x16_bf16 v[48:63], v[112:115], a[220:223], v[48:63]
    s_waitcnt lgkmcnt(1)
    v_mfma_f32_32x32x16_bf16 v[32:47], v[116:119], a[188:191], v[32:47]
    v_mfma_f32_32x32x16_bf16 v[48:63], v[116:119], a[224:227], v[48:63]
    s_waitcnt lgkmcnt(0)
    v_mfma_f32_32x32x16_bf16 v[32:47], v[120:123], a[192:195], v[32:47]
    v_mfma_f32_32x32x16_bf16 v[48:63], v[120:123], a[228:231], v[48:63]
    s_add_u32 m0, s13, 110592
    s_nop 0
    buffer_load_dwordx4 v206, s[4:7], s12 offen offset:0 sc1 lds
    buffer_load_dwordx4 v206, s[4:7], s12 offen offset:1024 sc1 lds
    buffer_load_dwordx4 v206, s[4:7], s12 offen offset:2048 sc1 lds
    buffer_load_dwordx4 v206, s[4:7], s12 offen offset:3072 sc1 lds
    s_add_u32 m0, s13, 114688
    s_nop 0
    buffer_load_dwordx4 v207, s[4:7], s12 offen offset:0 sc1 lds
    buffer_load_dwordx4 v207, s[4:7], s12 offen offset:1024 sc1 lds
    buffer_load_dwordx4 v207, s[4:7], s12 offen offset:2048 sc1 lds
    ds_read_b64_tr_b16 v[124:125], v194 offset:36864
    ds_read_b64_tr_b16 v[126:127], v194 offset:37120
    buffer_load_dwordx4 v207, s[4:7], s12 offen offset:3072 sc1 lds
    ds_read_b64_tr_b16 v[128:129], v195 offset:37888
    s_add_u32 m0, s13, 118784
    ds_read_b64_tr_b16 v[130:131], v195 offset:38144
    buffer_load_dwordx4 v208, s[4:7], s12 offen offset:0 sc1 lds
    ds_read_b64_tr_b16 v[132:133], v194 offset:38912
    s_add_u32 s12, s12, 9216
    ds_read_b64_tr_b16 v[134:135], v194 offset:39168
    ds_read_b64_tr_b16 v[136:137], v195 offset:39936
    s_waitcnt vmcnt(9)
    ds_read_b128 v[112:115], v192 offset:0
    ds_read_b64_tr_b16 v[138:139], v195 offset:40192
    ds_read_b64_tr_b16 v[140:141], v194 offset:40960
    buffer_load_dword v210, v216, s[24:27], 0 offen sc1
    ds_read_b128 v[116:119], v193 offset:1024
    ds_read_b64_tr_b16 v[142:143], v194 offset:41216
    ds_read_b64_tr_b16 v[144:145], v195 offset:41984
    ds_read_b128 v[120:123], v192 offset:2048
    ds_read_b64_tr_b16 v[146:147], v195 offset:42240
    ds_read_b64_tr_b16 v[148:149], v194 offset:43008
    ds_read_b64_tr_b16 v[150:151], v194 offset:43264
    ds_read_b64_tr_b16 v[152:153], v195 offset:44032
    ds_read_b64_tr_b16 v[154:155], v195 offset:44288
    s_nop 7
    s_nop 3
    s_branch Lk_b1
Lk_loop:
    s_waitcnt lgkmcnt(11)
    v_mfma_f32_32x32x16_bf16 v[32:47], v[112:115], a[160:163], v[64:79]
    v_exp_f32 v0, v0
    v_exp_f32 v1, v1
    v_exp_f32 v2, v2
    v_mfma_f32_32x32x16_bf16 v[48:63], v[112:115], a[196:199], v[80:95]
    ds_read_b128 v[112:115], v191 offset:39936
    v_cvt_pk_bf16_f32 v96, v0, v1
    v_exp_f32 v3, v3
    s_waitcnt lgkmcnt(9)
    v_mfma_f32_32x32x16_bf16 v[32:47], v[116:119], a[164:167], v[32:47]
    ds_read_b64_tr_b16 v[156:157], v194 offset:8192
    v_exp_f32 v4, v4
    v_cvt_pk_bf16_f32 v97, v2, v3
    v_exp_f32 v5, v5
    v_mfma_f32_32x32x16_bf16 v[48:63], v[116:119], a[200:203], v[48:63]
    ds_read_b128 v[116:119], v190 offset:40960
    v_exp_f32 v6, v6
    v_cvt_pk_bf16_f32 v100, v4, v5
    s_waitcnt lgkmcnt(8)
    v_mfma_f32_32x32x16_bf16 v[32:47], v[120:123], a[168:171], v[32:47]
    ds_read_b64_tr_b16 v[158:159], v194 offset:8448
    v_exp_f32 v7, v7
    v_exp_f32 v8, v8
    v_cvt_pk_bf16_f32 v101, v6, v7
    v_mfma_f32_32x32x16_bf16 v[48:63], v[120:123], a[204:207], v[48:63]
    ds_read_b128 v[120:123], v191 offset:41984
    v_exp_f32 v9, v9
    v_exp_f32 v10, v10
    s_waitcnt lgkmcnt(4)
    v_mfma_f32_32x32x16_bf16 v[32:47], v[112:115], a[172:175], v[32:47]
    v_cvt_pk_bf16_f32 v98, v8, v9
    v_exp_f32 v11, v11
    v_exp_f32 v12, v12
    v_cvt_pk_bf16_f32 v99, v10, v11
    v_mfma_f32_32x32x16_bf16 v[48:63], v[112:115], a[208:211], v[48:63]
    ds_read_b128 v[112:115], v190 offset:43008
    v_exp_f32 v13, v13
    v_exp_f32 v14, v14
    s_waitcnt lgkmcnt(3)
    v_mfma_f32_32x32x16_bf16 v[32:47], v[116:119], a[176:179], v[32:47]
    v_cvt_pk_bf16_f32 v102, v12, v13
    v_exp_f32 v15, v15
    v_permlane16_swap_b32 v96, v100
    v_cvt_pk_bf16_f32 v103, v14, v15
    v_permlane16_swap_b32 v97, v101
    v_mfma_f32_32x32x16_bf16 v[48:63], v[116:119], a[212:215], v[48:63]
    ds_read_b128 v[116:119], v191 offset:44032
    v_permlane16_swap_b32 v98, v102
    v_permlane16_swap_b32 v99, v103
    v_exp_f32 v16, v16
    s_waitcnt lgkmcnt(2)
    v_mfma_f32_32x32x16_bf16 v[32:47], v[120:123], a[180:183], v[32:47]
    v_exp_f32 v17, v17
    v_exp_f32 v18, v18
    v_cvt_pk_bf16_f32 v104, v16, v17
    v_mfma_f32_32x32x16_bf16 v[48:63], v[120:123], a[216:219], v[48:63]
    ds_read_b128 v[120:123], v190 offset:45056
    v_exp_f32 v19, v19
    v_exp_f32 v20, v20
    s_waitcnt lgkmcnt(2)
    v_mfma_f32_32x32x16_bf16 v[32:47], v[112:115], a[184:187], v[32:47]
    v_cvt_pk_bf16_f32 v105, v18, v19
    v_exp_f32 v21, v21
    v_exp_f32 v22, v22
    v_cvt_pk_bf16_f32 v108, v20, v21
    v_mfma_f32_32x32x16_bf16 v[48:63], v[112:115], a[220:223], v[48:63]
    v_exp_f32 v23, v23
    v_exp_f32 v24, v24
    v_cvt_pk_bf16_f32 v109, v22, v23
    s_waitcnt lgkmcnt(1)
    v_mfma_f32_32x32x16_bf16 v[32:47], v[116:119], a[188:191], v[32:47]
    v_exp_f32 v25, v25
    v_exp_f32 v26, v26
    v_cvt_pk_bf16_f32 v106, v24, v25
    v_mfma_f32_32x32x16_bf16 v[48:63], v[116:119], a[224:227], v[48:63]
    v_exp_f32 v27, v27
    v_exp_f32 v28, v28
    v_cvt_pk_bf16_f32 v107, v26, v27
    s_waitcnt lgkmcnt(0)
    v_mfma_f32_32x32x16_bf16 v[32:47], v[120:123], a[192:195], v[32:47]
    v_exp_f32 v29, v29
    v_exp_f32 v30, v30
    v_cvt_pk_bf16_f32 v110, v28, v29
    v_mfma_f32_32x32x16_bf16 v[48:63], v[120:123], a[228:231], v[48:63]
    v_exp_f32 v31, v31
    v_permlane16_swap_b32 v104, v108
    v_cvt_pk_bf16_f32 v111, v30, v31
    v_permlane16_swap_b32 v105, v109
    v_permlane16_swap_b32 v106, v110
    v_mfma_f32_16x16x32_bf16 a[0:3], v[124:127], v[96:99], a[0:3]
    s_add_u32 m0, s13, 110592
    v_permlane16_swap_b32 v107, v111
    v_mfma_f32_16x16x32_bf16 a[4:7], v[124:127], v[100:103], a[4:7]
    buffer_load_dwordx4 v206, s[4:7], s12 offen offset:0 sc1 lds
    v_mfma_f32_16x16x32_bf16 a[8:11], v[128:131], v[96:99], a[8:11]
    v_mfma_f32_16x16x32_bf16 a[12:15], v[128:131], v[100:103], a[12:15]
    v_add_f32 v161, v161, v1
    v_add_f32 v160, v160, v2
    v_mfma_f32_16x16x32_bf16 a[16:19], v[132:135], v[96:99], a[16:19]
    buffer_load_dwordx4 v206, s[4:7], s12 offen offset:1024 sc1 lds
    v_add_f32 v160, v160, v0
    v_mfma_f32_16x16x32_bf16 a[20:23], v[132:135], v[100:103], a[20:23]
    v_add_f32 v161, v161, v5
    v_add_f32 v161, v161, v3
    v_mfma_f32_16x16x32_bf16 a[24:27], v[136:139], v[96:99], a[24:27]
    v_add_f32 v160, v160, v6
    v_add_f32 v160, v160, v4
    v_mfma_f32_16x16x32_bf16 a[28:31], v[136:139], v[100:103], a[28:31]
    buffer_load_dwordx4 v206, s[4:7], s12 offen offset:2048 sc1 lds
    v_add_f32 v160, v160, v8
    v_mfma_f32_16x16x32_bf16 a[32:35], v[140:143], v[96:99], a[32:35]
    v_add_f32 v160, v160, v10
    v_add_f32 v161, v161, v7
    v_mfma_f32_16x16x32_bf16 a[36:39], v[140:143], v[100:103], a[36:39]
    v_add_f32 v160, v160, v12
    v_add_f32 v161, v161, v9
    v_mfma_f32_16x16x32_bf16 a[40:43], v[144:147], v[96:99], a[40:43]
    buffer_load_dwordx4 v206, s[4:7], s12 offen offset:3072 sc1 lds
    v_add_f32 v161, v161, v11
    v_mfma_f32_16x16x32_bf16 a[44:47], v[144:147], v[100:103], a[44:47]
    v_add_f32 v161, v161, v13
    v_add_f32 v160, v160, v14
    v_mfma_f32_16x16x32_bf16 a[48:51], v[148:151], v[96:99], a[48:51]
    s_add_u32 m0, s13, 114688
    v_add_f32 v161, v161, v15
    v_mfma_f32_16x16x32_bf16 a[52:55], v[148:151], v[100:103], a[52:55]
    buffer_load_dwordx4 v207, s[4:7], s12 offen offset:0 sc1 lds
    v_add_f32 v162, v162, v16
    v_mfma_f32_16x16x32_bf16 a[56:59], v[152:155], v[96:99], a[56:59]
    v_add_f32 v163, v163, v17
    v_add_f32 v162, v162, v18
    v_mfma_f32_16x16x32_bf16 a[60:63], v[152:155], v[100:103], a[60:63]
    v_add_f32 v163, v163, v19
    v_add_f32 v162, v162, v20
    v_mfma_f32_16x16x32_bf16 a[64:67], v[156:159], v[96:99], a[64:67]
    buffer_load_dwordx4 v207, s[4:7], s12 offen offset:1024 sc1 lds
    v_add_f32 v162, v162, v22
    v_mfma_f32_16x16x32_bf16 a[68:71], v[156:159], v[100:103], a[68:71]
    v_add_f32 v162, v162, v24
    v_add_f32 v163, v163, v21
    v_mfma_f32_16x16x32_bf16 a[80:83], v[124:127], v[104:107], a[80:83]
    v_add_f32 v162, v162, v26
    v_add_f32 v163, v163, v23
    v_mfma_f32_16x16x32_bf16 a[84:87], v[124:127], v[108:111], a[84:87]
    buffer_load_dwordx4 v207, s[4:7], s12 offen offset:2048 sc1 lds
    v_add_f32 v163, v163, v25
    v_mfma_f32_16x16x32_bf16 a[88:91], v[128:131], v[104:107], a[88:91]
    ds_read_b64_tr_b16 v[124:125], v194 offset:36864
    v_add_f32 v162, v162, v28
    v_mfma_f32_16x16x32_bf16 a[92:95], v[128:131], v[108:111], a[92:95]
    ds_read_b64_tr_b16 v[126:127], v194 offset:37120
    buffer_load_dwordx4 v207, s[4:7], s12 offen offset:3072 sc1 lds
    v_mfma_f32_16x16x32_bf16 a[96:99], v[132:135], v[104:107], a[96:99]
    ds_read_b64_tr_b16 v[128:129], v195 offset:37888
    s_add_u32 m0, s13, 118784
    v_mfma_f32_16x16x32_bf16 a[100:103], v[132:135], v[108:111], a[100:103]
    ds_read_b64_tr_b16 v[130:131], v195 offset:38144
    buffer_load_dwordx4 v208, s[4:7], s12 offen offset:0 sc1 lds
    v_mfma_f32_16x16x32_bf16 a[104:107], v[136:139], v[104:107], a[104:107]
    ds_read_b64_tr_b16 v[132:133], v194 offset:38912
    s_add_u32 s12, s12, 9216
    v_mfma_f32_16x16x32_bf16 a[108:111], v[136:139], v[108:111], a[108:111]
    ds_read_b64_tr_b16 v[134:135], v194 offset:39168
    s_cmp_eq_u32 s14, 1
    v_mfma_f32_16x16x32_bf16 a[112:115], v[140:143], v[104:107], a[112:115]
    ds_read_b64_tr_b16 v[136:137], v195 offset:39936
    s_cselect_b32 s12, s73, s12
    v_mfma_f32_16x16x32_bf16 a[116:119], v[140:143], v[108:111], a[116:119]
    s_waitcnt vmcnt(9)
    ds_read_b128 v[112:115], v192 offset:0
    ds_read_b64_tr_b16 v[138:139], v195 offset:40192
    v_mfma_f32_16x16x32_bf16 a[120:123], v[144:147], v[104:107], a[120:123]
    ds_read_b64_tr_b16 v[140:141], v194 offset:40960
    buffer_load_dword v210, v216, s[24:27], 0 offen sc1
    v_mfma_f32_16x16x32_bf16 a[124:127], v[144:147], v[108:111], a[124:127]
    ds_read_b128 v[116:119], v193 offset:1024
    ds_read_b64_tr_b16 v[142:143], v194 offset:41216
    v_mfma_f32_16x16x32_bf16 a[128:131], v[148:151], v[104:107], a[128:131]
    ds_read_b64_tr_b16 v[144:145], v195 offset:41984
    v_add_f32 v163, v163, v27
    v_mfma_f32_16x16x32_bf16 a[132:135], v[148:151], v[108:111], a[132:135]
    ds_read_b128 v[120:123], v192 offset:2048
    ds_read_b64_tr_b16 v[146:147], v195 offset:42240
    v_mfma_f32_16x16x32_bf16 a[136:139], v[152:155], v[104:107], a[136:139]
    ds_read_b64_tr_b16 v[148:149], v194 offset:43008
    v_add_f32 v162, v162, v30
    v_mfma_f32_16x16x32_bf16 a[140:143], v[152:155], v[108:111], a[140:143]
    ds_read_b64_tr_b16 v[150:151], v194 offset:43264
    v_add_f32 v163, v163, v29
    v_mfma_f32_16x16x32_bf16 a[144:147], v[156:159], v[104:107], a[144:147]
    ds_read_b64_tr_b16 v[152:153], v195 offset:44032
    v_add_f32 v163, v163, v31
    v_mfma_f32_16x16x32_bf16 a[148:151], v[156:159], v[108:111], a[148:151]
    ds_read_b64_tr_b16 v[154:155], v195 offset:44288
Lk_b1:
    s_waitcnt lgkmcnt(11)
    v_mfma_f32_32x32x16_bf16 v[0:15], v[112:115], a[160:163], v[64:79]
    v_exp_f32 v32, v32
    v_exp_f32 v33, v33
    v_exp_f32 v34, v34
    v_mfma_f32_32x32x16_bf16 v[16:31], v[112:115], a[196:199], v[80:95]
    ds_read_b128 v[112:115], v193 offset:3072
    v_cvt_pk_bf16_f32 v96, v32, v33
    v_exp_f32 v35, v35
    s_waitcnt lgkmcnt(9)
    v_mfma_f32_32x32x16_bf16 v[0:15], v[116:119], a[164:167], v[0:15]
    ds_read_b64_tr_b16 v[156:157], v194 offset:45056
    v_exp_f32 v36, v36
    v_cvt_pk_bf16_f32 v97, v34, v35
    v_exp_f32 v37, v37
    v_mfma_f32_32x32x16_bf16 v[16:31], v[116:119], a[200:203], v[16:31]
    ds_read_b128 v[116:119], v192 offset:4096
    v_exp_f32 v38, v38
    v_cvt_pk_bf16_f32 v100, v36, v37
    s_waitcnt lgkmcnt(8)
    v_mfma_f32_32x32x16_bf16 v[0:15], v[120:123], a[168:171], v[0:15]
    ds_read_b64_tr_b16 v[158:159], v194 offset:45312
    v_exp_f32 v39, v39
    v_exp_f32 v40, v40
    v_cvt_pk_bf16_f32 v101, v38, v39
    v_mfma_f32_32x32x16_bf16 v[16:31], v[120:123], a[204:207], v[16:31]
    ds_read_b128 v[120:123], v193 offset:5120
    v_exp_f32 v41, v41
    v_exp_f32 v42, v42
    s_waitcnt lgkmcnt(4)
    v_mfma_f32_32x32x16_bf16 v[0:15], v[112:115], a[172:175], v[0:15]
    v_cvt_pk_bf16_f32 v98, v40, v41
    v_exp_f32 v43, v43
    v_exp_f32 v44, v44
    v_cvt_pk_bf16_f32 v99, v42, v43
    v_mfma_f32_32x32x16_bf16 v[16:31], v[112:115], a[208:211], v[16:31]
    ds_read_b128 v[112:115], v192 offset:6144
    v_exp_f32 v45, v45
    v_exp_f32 v46, v46
    s_waitcnt lgkmcnt(3)
    v_mfma_f32_32x32x16_bf16 v[0:15], v[116:119], a[176:179], v[0:15]
    v_cvt_pk_bf16_f32 v102, v44, v45
    v_exp_f32 v47, v47
    v_permlane16_swap_b32 v96, v100
    v_cvt_pk_bf16_f32 v103, v46, v47
    v_permlane16_swap_b32 v97, v101
    v_mfma_f32_32x32x16_bf16 v[16:31], v[116:119], a[212:215], v[16:31]
    ds_read_b128 v[116:119], v193 offset:7168
    v_permlane16_swap_b32 v98, v102
    v_permlane16_swap_b32 v99, v103
    v_exp_f32 v48, v48
    s_waitcnt lgkmcnt(2)
    v_mfma_f32_32x32x16_bf16 v[0:15], v[120:123], a[180:183], v[0:15]
    v_exp_f32 v49, v49
    v_exp_f32 v50, v50
    v_cvt_pk_bf16_f32 v104, v48, v49
    v_mfma_f32_32x32x16_bf16 v[16:31], v[120:123], a[216:219], v[16:31]
    ds_read_b128 v[120:123], v192 offset:8192
    v_exp_f32 v51, v51
    v_exp_f32 v52, v52
    s_waitcnt lgkmcnt(2)
    v_mfma_f32_32x32x16_bf16 v[0:15], v[112:115], a[184:187], v[0:15]
    v_cvt_pk_bf16_f32 v105, v50, v51
    v_exp_f32 v53, v53
    v_exp_f32 v54, v54
    v_cvt_pk_bf16_f32 v108, v52, v53
    v_mfma_f32_32x32x16_bf16 v[16:31], v[112:115], a[220:223], v[16:31]
    v_exp_f32 v55, v55
    v_exp_f32 v56, v56
    v_cvt_pk_bf16_f32 v109, v54, v55
    s_waitcnt lgkmcnt(1)
    v_mfma_f32_32x32x16_bf16 v[0:15], v[116:119], a[188:191], v[0:15]
    v_exp_f32 v57, v57
    v_exp_f32 v58, v58
    v_cvt_pk_bf16_f32 v106, v56, v57
    v_mfma_f32_32x32x16_bf16 v[16:31], v[116:119], a[224:227], v[16:31]
    v_exp_f32 v59, v59
    v_exp_f32 v60, v60
    v_cvt_pk_bf16_f32 v107, v58, v59
    s_waitcnt lgkmcnt(0)
    v_mfma_f32_32x32x16_bf16 v[0:15], v[120:123], a[192:195], v[0:15]
    v_exp_f32 v61, v61
    v_exp_f32 v62, v62
    v_cvt_pk_bf16_f32 v110, v60, v61
    v_mfma_f32_32x32x16_bf16 v[16:31], v[120:123], a[228:231], v[16:31]
    v_exp_f32 v63, v63
    v_permlane16_swap_b32 v104, v108
    v_cvt_pk_bf16_f32 v111, v62, v63
    v_permlane16_swap_b32 v105, v109
    v_permlane16_swap_b32 v106, v110
    v_mfma_f32_16x16x32_bf16 a[0:3], v[124:127], v[96:99], a[0:3]
    s_add_u32 m0, s13, 0
    v_permlane16_swap_b32 v107, v111
    v_mfma_f32_16x16x32_bf16 a[4:7], v[124:127], v[100:103], a[4:7]
    buffer_load_dwordx4 v206, s[4:7], s12 offen offset:0 sc1 lds
    v_mfma_f32_16x16x32_bf16 a[8:11], v[128:131], v[96:99], a[8:11]
    v_mfma_f32_16x16x32_bf16 a[12:15], v[128:131], v[100:103], a[12:15]
    v_add_f32 v161, v161, v33
    v_add_f32 v160, v160, v34
    v_mfma_f32_16x16x32_bf16 a[16:19], v[132:135], v[96:99], a[16:19]
    buffer_load_dwordx4 v206, s[4:7], s12 offen offset:1024 sc1 lds
    v_add_f32 v160, v160, v32
    v_mfma_f32_16x16x32_bf16 a[20:23], v[132:135], v[100:103], a[20:23]
    v_add_f32 v161, v161, v37
    v_add_f32 v161, v161, v35
    v_mfma_f32_16x16x32_bf16 a[24:27], v[136:139], v[96:99], a[24:27]
    v_add_f32 v160, v160, v38
    v_add_f32 v160, v160, v36
    v_mfma_f32_16x16x32_bf16 a[28:31], v[136:139], v[100:103], a[28:31]
    buffer_load_dwordx4 v206, s[4:7], s12 offen offset:2048 sc1 lds
    v_add_f32 v160, v160, v40
    v_mfma_f32_16x16x32_bf16 a[32:35], v[140:143], v[96:99], a[32:35]
    v_add_f32 v160, v160, v42
    v_add_f32 v161, v161, v39
    v_mfma_f32_16x16x32_bf16 a[36:39], v[140:143], v[100:103], a[36:39]
    v_add_f32 v160, v160, v44
    v_add_f32 v161, v161, v41
    v_mfma_f32_16x16x32_bf16 a[40:43], v[144:147], v[96:99], a[40:43]
    buffer_load_dwordx4 v206, s[4:7], s12 offen offset:3072 sc1 lds
    v_add_f32 v161, v161, v43
    v_mfma_f32_16x16x32_bf16 a[44:47], v[144:147], v[100:103], a[44:47]
    v_add_f32 v161, v161, v45
    v_add_f32 v160, v160, v46
    v_mfma_f32_16x16x32_bf16 a[48:51], v[148:151], v[96:99], a[48:51]
    s_add_u32 m0, s13, 4096
    v_add_f32 v161, v161, v47
    v_mfma_f32_16x16x32_bf16 a[52:55], v[148:151], v[100:103], a[52:55]
    buffer_load_dwordx4 v207, s[4:7], s12 offen offset:0 sc1 lds
    v_add_f32 v162, v162, v48
    v_mfma_f32_16x16x32_bf16 a[56:59], v[152:155], v[96:99], a[56:59]
    v_add_f32 v163, v163, v49
    v_add_f32 v162, v162, v50
    v_mfma_f32_16x16x32_bf16 a[60:63], v[152:155], v[100:103], a[60:63]
    v_add_f32 v163, v163, v51
    v_add_f32 v162, v162, v52
    v_mfma_f32_16x16x32_bf16 a[64:67], v[156:159], v[96:99], a[64:67]
    buffer_load_dwordx4 v207, s[4:7], s12 offen offset:1024 sc1 lds
    v_add_f32 v162, v162, v54
    v_mfma_f32_16x16x32_bf16 a[68:71], v[156:159], v[100:103], a[68:71]
    v_add_f32 v162, v162, v56
    v_add_f32 v163, v163, v53
    v_mfma_f32_16x16x32_bf16 a[80:83], v[124:127], v[104:107], a[80:83]
    v_add_f32 v162, v162, v58
    v_add_f32 v163, v163, v55
    v_mfma_f32_16x16x32_bf16 a[84:87], v[124:127], v[108:111], a[84:87]
    buffer_load_dwordx4 v207, s[4:7], s12 offen offset:2048 sc1 lds
    v_add_f32 v163, v163, v57
    v_mfma_f32_16x16x32_bf16 a[88:91], v[128:131], v[104:107], a[88:91]
    ds_read_b64_tr_b16 v[124:125], v196 offset:0
    v_add_f32 v162, v162, v60
    v_mfma_f32_16x16x32_bf16 a[92:95], v[128:131], v[108:111], a[92:95]
    ds_read_b64_tr_b16 v[126:127], v196 offset:256
    buffer_load_dwordx4 v207, s[4:7], s12 offen offset:3072 sc1 lds
    v_mfma_f32_16x16x32_bf16 a[96:99], v[132:135], v[104:107], a[96:99]
    ds_read_b64_tr_b16 v[128:129], v197 offset:1024
    s_add_u32 m0, s13, 8192
    v_mfma_f32_16x16x32_bf16 a[100:103], v[132:135], v[108:111], a[100:103]
    ds_read_b64_tr_b16 v[130:131], v197 offset:1280
    buffer_load_dwordx4 v208, s[4:7], s12 offen offset:0 sc1 lds
    v_mfma_f32_16x16x32_bf16 a[104:107], v[136:139], v[104:107], a[104:107]
    ds_read_b64_tr_b16 v[132:133], v196 offset:2048
    s_add_u32 s12, s12, 9216
    v_mfma_f32_16x16x32_bf16 a[108:111], v[136:139], v[108:111], a[108:111]
    ds_read_b64_tr_b16 v[134:135], v196 offset:2304
    s_cmp_eq_u32 s14, 1
    v_mfma_f32_16x16x32_bf16 a[112:115], v[140:143], v[104:107], a[112:115]
    ds_read_b64_tr_b16 v[136:137], v197 offset:3072
    s_cselect_b32 s12, s74, s12
    v_mfma_f32_16x16x32_bf16 a[116:119], v[140:143], v[108:111], a[116:119]
    s_waitcnt vmcnt(10)
    ds_read_b128 v[112:115], v192 offset:36864
    ds_read_b64_tr_b16 v[138:139], v197 offset:3328
    v_mfma_f32_16x16x32_bf16 a[120:123], v[144:147], v[104:107], a[120:123]
    ds_read_b64_tr_b16 v[140:141], v196 offset:4096
    buffer_store_dword v221, v222, s[28:31], s76 offen sc1
    v_mfma_f32_16x16x32_bf16 a[124:127], v[144:147], v[108:111], a[124:127]
    ds_read_b128 v[116:119], v193 offset:37888
    ds_read_b64_tr_b16 v[142:143], v196 offset:4352
    v_mfma_f32_16x16x32_bf16 a[128:131], v[148:151], v[104:107], a[128:131]
    ds_read_b64_tr_b16 v[144:145], v197 offset:5120
    v_add_f32 v163, v163, v59
    v_mfma_f32_16x16x32_bf16 a[132:135], v[148:151], v[108:111], a[132:135]
    ds_read_b128 v[120:123], v192 offset:38912
    ds_read_b64_tr_b16 v[146:147], v197 offset:5376
    v_mfma_f32_16x16x32_bf16 a[136:139], v[152:155], v[104:107], a[136:139]
    ds_read_b64_tr_b16 v[148:149], v196 offset:6144
    v_add_f32 v162, v162, v62
    v_mfma_f32_16x16x32_bf16 a[140:143], v[152:155], v[108:111], a[140:143]
    ds_read_b64_tr_b16 v[150:151], v196 offset:6400
    v_add_f32 v163, v163, v61
    v_mfma_f32_16x16x32_bf16 a[144:147], v[156:159], v[104:107], a[144:147]
    ds_read_b64_tr_b16 v[152:153], v197 offset:7168
    v_add_f32 v163, v163, v63
    v_mfma_f32_16x16x32_bf16 a[148:151], v[156:159], v[108:111], a[148:151]
    ds_read_b64_tr_b16 v[154:155], v197 offset:7424
    s_waitcnt lgkmcnt(11)
    v_mfma_f32_32x32x16_bf16 v[32:47], v[112:115], a[160:163], v[64:79]
    v_exp_f32 v0, v0
    v_exp_f32 v1, v1
    v_exp_f32 v2, v2
    v_mfma_f32_32x32x16_bf16 v[48:63], v[112:115], a[196:199], v[80:95]
    ds_read_b128 v[112:115], v193 offset:39936
    v_cvt_pk_bf16_f32 v96, v0, v1
    v_exp_f32 v3, v3
    s_waitcnt lgkmcnt(9)
    v_mfma_f32_32x32x16_bf16 v[32:47], v[116:119], a[164:167], v[32:47]
    ds_read_b64_tr_b16 v[156:157], v196 offset:8192
    v_exp_f32 v4, v4
    v_cvt_pk_bf16_f32 v97, v2, v3
    v_exp_f32 v5, v5
    v_mfma_f32_32x32x16_bf16 v[48:63], v[116:119], a[200:203], v[48:63]
    ds_read_b128 v[116:119], v192 offset:40960
    v_exp_f32 v6, v6
    v_cvt_pk_bf16_f32 v100, v4, v5
    s_waitcnt lgkmcnt(8)
    v_mfma_f32_32x32x16_bf16 v[32:47], v[120:123], a[168:171], v[32:47]
    ds_read_b64_tr_b16 v[158:159], v196 offset:8448
    v_exp_f32 v7, v7
    v_exp_f32 v8, v8
    v_cvt_pk_bf16_f32 v101, v6, v7
    v_mfma_f32_32x32x16_bf16 v[48:63], v[120:123], a[204:207], v[48:63]
    ds_read_b128 v[120:123], v193 offset:41984
    v_exp_f32 v9, v9
    v_exp_f32 v10, v10
    s_waitcnt lgkmcnt(4)
    v_mfma_f32_32x32x16_bf16 v[32:47], v[112:115], a[172:175], v[32:47]
    v_cvt_pk_bf16_f32 v98, v8, v9
    v_exp_f32 v11, v11
    v_exp_f32 v12, v12
    v_cvt_pk_bf16_f32 v99, v10, v11
    v_mfma_f32_32x32x16_bf16 v[48:63], v[112:115], a[208:211], v[48:63]
    ds_read_b128 v[112:115], v192 offset:43008
    v_exp_f32 v13, v13
    v_exp_f32 v14, v14
    s_waitcnt lgkmcnt(3)
    v_mfma_f32_32x32x16_bf16 v[32:47], v[116:119], a[176:179], v[32:47]
    v_cvt_pk_bf16_f32 v102, v12, v13
    v_exp_f32 v15, v15
    v_permlane16_swap_b32 v96, v100
    v_cvt_pk_bf16_f32 v103, v14, v15
    v_permlane16_swap_b32 v97, v101
    v_mfma_f32_32x32x16_bf16 v[48:63], v[116:119], a[212:215], v[48:63]
    ds_read_b128 v[116:119], v193 offset:44032
    v_permlane16_swap_b32 v98, v102
    v_permlane16_swap_b32 v99, v103
    v_exp_f32 v16, v16
    s_waitcnt lgkmcnt(2)
    v_mfma_f32_32x32x16_bf16 v[32:47], v[120:123], a[180:183], v[32:47]
    v_exp_f32 v17, v17
    v_exp_f32 v18, v18
    v_cvt_pk_bf16_f32 v104, v16, v17
    v_mfma_f32_32x32x16_bf16 v[48:63], v[120:123], a[216:219], v[48:63]
    ds_read_b128 v[120:123], v192 offset:45056
    v_exp_f32 v19, v19
    v_exp_f32 v20, v20
    s_waitcnt lgkmcnt(2)
    v_mfma_f32_32x32x16_bf16 v[32:47], v[112:115], a[184:187], v[32:47]
    v_cvt_pk_bf16_f32 v105, v18, v19
    v_exp_f32 v21, v21
    v_exp_f32 v22, v22
    v_cvt_pk_bf16_f32 v108, v20, v21
    v_mfma_f32_32x32x16_bf16 v[48:63], v[112:115], a[220:223], v[48:63]
    v_exp_f32 v23, v23
    v_exp_f32 v24, v24
    v_cvt_pk_bf16_f32 v109, v22, v23
    s_waitcnt lgkmcnt(1)
    v_mfma_f32_32x32x16_bf16 v[32:47], v[116:119], a[188:191], v[32:47]
    v_exp_f32 v25, v25
    v_exp_f32 v26, v26
    v_cvt_pk_bf16_f32 v106, v24, v25
    v_mfma_f32_32x32x16_bf16 v[48:63], v[116:119], a[224:227], v[48:63]
    v_exp_f32 v27, v27
    v_exp_f32 v28, v28
    v_cvt_pk_bf16_f32 v107, v26, v27
    s_waitcnt lgkmcnt(0)
    v_mfma_f32_32x32x16_bf16 v[32:47], v[120:123], a[192:195], v[32:47]
    v_exp_f32 v29, v29
    v_exp_f32 v30, v30
    v_cvt_pk_bf16_f32 v110, v28, v29
    v_mfma_f32_32x32x16_bf16 v[48:63], v[120:123], a[228:231], v[48:63]
    v_exp_f32 v31, v31
    v_permlane16_swap_b32 v104, v108
    v_cvt_pk_bf16_f32 v111, v30, v31
    v_permlane16_swap_b32 v105, v109
    v_permlane16_swap_b32 v106, v110
    v_mfma_f32_16x16x32_bf16 a[0:3], v[124:127], v[96:99], a[0:3]
    s_add_u32 m0, s13, 36864
    v_permlane16_swap_b32 v107, v111
    v_mfma_f32_16x16x32_bf16 a[4:7], v[124:127], v[100:103], a[4:7]
    buffer_load_dwordx4 v206, s[4:7], s12 offen offset:0 sc1 lds
    v_mfma_f32_16x16x32_bf16 a[8:11], v[128:131], v[96:99], a[8:11]
    v_mfma_f32_16x16x32_bf16 a[12:15], v[128:131], v[100:103], a[12:15]
    v_mfma_f32_16x16x32_bf16 a[16:19], v[132:135], v[96:99], a[16:19]
    buffer_load_dwordx4 v206, s[4:7], s12 offen offset:1024 sc1 lds
    v_mfma_f32_16x16x32_bf16 a[20:23], v[132:135], v[100:103], a[20:23]
    v_add_f32 v161, v161, v1
    v_add_f32 v160, v160, v2
    v_mfma_f32_16x16x32_bf16 a[24:27], v[136:139], v[96:99], a[24:27]
    v_add_f32 v161, v161, v3
    v_add_f32 v160, v160, v0
    v_mfma_f32_16x16x32_bf16 a[28:31], v[136:139], v[100:103], a[28:31]
    buffer_load_dwordx4 v206, s[4:7], s12 offen offset:2048 sc1 lds
    v_add_f32 v161, v161, v5
    v_mfma_f32_16x16x32_bf16 a[32:35], v[140:143], v[96:99], a[32:35]
    v_add_f32 v160, v160, v6
    v_add_f32 v160, v160, v4
    v_mfma_f32_16x16x32_bf16 a[36:39], v[140:143], v[100:103], a[36:39]
    v_add_f32 v161, v161, v7
    v_add_f32 v160, v160, v8
    v_mfma_f32_16x16x32_bf16 a[40:43], v[144:147], v[96:99], a[40:43]
    buffer_load_dwordx4 v206, s[4:7], s12 offen offset:3072 sc1 lds
    v_add_f32 v160, v160, v10
    v_mfma_f32_16x16x32_bf16 a[44:47], v[144:147], v[100:103], a[44:47]
    v_add_f32 v160, v160, v12
    v_add_f32 v161, v161, v9
    v_mfma_f32_16x16x32_bf16 a[48:51], v[148:151], v[96:99], a[48:51]
    s_add_u32 m0, s13, 40960
    v_add_f32 v161, v161, v11
    v_mfma_f32_16x16x32_bf16 a[52:55], v[148:151], v[100:103], a[52:55]
    buffer_load_dwordx4 v207, s[4:7], s12 offen offset:0 sc1 lds
    v_add_f32 v160, v160, v14
    v_mfma_f32_16x16x32_bf16 a[56:59], v[152:155], v[96:99], a[56:59]
    v_add_f32 v161, v161, v15
    v_add_f32 v161, v161, v13
    v_mfma_f32_16x16x32_bf16 a[60:63], v[152:155], v[100:103], a[60:63]
    v_add_f32 v162, v162, v18
    v_add_f32 v162, v162, v16
    v_mfma_f32_16x16x32_bf16 a[64:67], v[156:159], v[96:99], a[64:67]
    buffer_load_dwordx4 v207, s[4:7], s12 offen offset:1024 sc1 lds
    v_add_f32 v163, v163, v17
    v_mfma_f32_16x16x32_bf16 a[68:71], v[156:159], v[100:103], a[68:71]
    v_add_f32 v163, v163, v19
    v_add_f32 v162, v162, v20
    v_mfma_f32_16x16x32_bf16 a[80:83], v[124:127], v[104:107], a[80:83]
    v_add_f32 v163, v163, v21
    v_add_f32 v162, v162, v22
    v_mfma_f32_16x16x32_bf16 a[84:87], v[124:127], v[108:111], a[84:87]
    buffer_load_dwordx4 v207, s[4:7], s12 offen offset:2048 sc1 lds
    v_add_f32 v162, v162, v24
    v_mfma_f32_16x16x32_bf16 a[88:91], v[128:131], v[104:107], a[88:91]
    ds_read_b64_tr_b16 v[124:125], v196 offset:36864
    v_add_f32 v163, v163, v23
    v_mfma_f32_16x16x32_bf16 a[92:95], v[128:131], v[108:111], a[92:95]
    ds_read_b64_tr_b16 v[126:127], v196 offset:37120
    buffer_load_dwordx4 v207, s[4:7], s12 offen offset:3072 sc1 lds
    v_mfma_f32_16x16x32_bf16 a[96:99], v[132:135], v[104:107], a[96:99]
    ds_read_b64_tr_b16 v[128:129], v197 offset:37888
    s_add_u32 m0, s13, 45056
    v_mfma_f32_16x16x32_bf16 a[100:103], v[132:135], v[108:111], a[100:103]
    ds_read_b64_tr_b16 v[130:131], v197 offset:38144
    buffer_load_dwordx4 v208, s[4:7], s12 offen offset:0 sc1 lds
    v_mfma_f32_16x16x32_bf16 a[104:107], v[136:139], v[104:107], a[104:107]
    ds_read_b64_tr_b16 v[132:133], v196 offset:38912
    s_add_u32 s12, s12, 9216
    v_mfma_f32_16x16x32_bf16 a[108:111], v[136:139], v[108:111], a[108:111]
    ds_read_b64_tr_b16 v[134:135], v196 offset:39168
    v_add_f32 v162, v162, v26
    v_mfma_f32_16x16x32_bf16 a[112:115], v[140:143], v[104:107], a[112:115]
    ds_read_b64_tr_b16 v[136:137], v197 offset:39936
    v_add_f32 v163, v163, v25
    v_mfma_f32_16x16x32_bf16 a[116:119], v[140:143], v[108:111], a[116:119]
    s_waitcnt vmcnt(10)
    ds_read_b128 v[112:115], v190 offset:0
    ds_read_b64_tr_b16 v[138:139], v197 offset:40192
    v_mfma_f32_16x16x32_bf16 a[120:123], v[144:147], v[104:107], a[120:123]
    ds_read_b64_tr_b16 v[140:141], v196 offset:40960
    v_add_f32 v162, v162, v28
    v_mfma_f32_16x16x32_bf16 a[124:127], v[144:147], v[108:111], a[124:127]
    ds_read_b128 v[116:119], v191 offset:1024
    ds_read_b64_tr_b16 v[142:143], v196 offset:41216
    v_mfma_f32_16x16x32_bf16 a[128:131], v[148:151], v[104:107], a[128:131]
    ds_read_b64_tr_b16 v[144:145], v197 offset:41984
    v_add_f32 v163, v163, v27
    v_mfma_f32_16x16x32_bf16 a[132:135], v[148:151], v[108:111], a[132:135]
    ds_read_b128 v[120:123], v190 offset:2048
    ds_read_b64_tr_b16 v[146:147], v197 offset:42240
    v_mfma_f32_16x16x32_bf16 a[136:139], v[152:155], v[104:107], a[136:139]
    ds_read_b64_tr_b16 v[148:149], v196 offset:43008
    v_add_f32 v162, v162, v30
    v_mfma_f32_16x16x32_bf16 a[140:143], v[152:155], v[108:111], a[140:143]
    ds_read_b64_tr_b16 v[150:151], v196 offset:43264
    v_add_f32 v163, v163, v29
    v_mfma_f32_16x16x32_bf16 a[144:147], v[156:159], v[104:107], a[144:147]
    ds_read_b64_tr_b16 v[152:153], v197 offset:44032
    v_add_f32 v163, v163, v31
    v_mfma_f32_16x16x32_bf16 a[148:151], v[156:159], v[108:111], a[148:151]
    ds_read_b64_tr_b16 v[154:155], v197 offset:44288
    s_cmp_eq_u32 s14, 1
    s_cbranch_scc1 Lk_last
    s_waitcnt lgkmcnt(11)
    v_mfma_f32_32x32x16_bf16 v[0:15], v[112:115], a[160:163], v[64:79]
    v_exp_f32 v32, v32
    v_exp_f32 v33, v33
    v_exp_f32 v34, v34
    v_mfma_f32_32x32x16_bf16 v[16:31], v[112:115], a[196:199], v[80:95]
    ds_read_b128 v[112:115], v191 offset:3072
    v_cvt_pk_bf16_f32 v96, v32, v33
    v_exp_f32 v35, v35
    s_waitcnt lgkmcnt(9)
    v_mfma_f32_32x32x16_bf16 v[0:15], v[116:119], a[164:167], v[0:15]
    ds_read_b64_tr_b16 v[156:157], v196 offset:45056
    v_exp_f32 v36, v36
    v_cvt_pk_bf16_f32 v97, v34, v35
    v_exp_f32 v37, v37
    v_mfma_f32_32x32x16_bf16 v[16:31], v[116:119], a[200:203], v[16:31]
    ds_read_b128 v[116:119], v190 offset:4096
    v_exp_f32 v38, v38
    v_cvt_pk_bf16_f32 v100, v36, v37
    s_waitcnt lgkmcnt(8)
    v_mfma_f32_32x32x16_bf16 v[0:15], v[120:123], a[168:171], v[0:15]
    ds_read_b64_tr_b16 v[158:159], v196 offset:45312
    v_exp_f32 v39, v39
    v_exp_f32 v40, v40
    v_cvt_pk_bf16_f32 v101, v38, v39
    v_mfma_f32_32x32x16_bf16 v[16:31], v[120:123], a[204:207], v[16:31]
    ds_read_b128 v[120:123], v191 offset:5120
    v_exp_f32 v41, v41
    v_exp_f32 v42, v42
    s_waitcnt lgkmcnt(4)
    v_mfma_f32_32x32x16_bf16 v[0:15], v[112:115], a[172:175], v[0:15]
    v_cvt_pk_bf16_f32 v98, v40, v41
    v_exp_f32 v43, v43
    v_exp_f32 v44, v44
    v_cvt_pk_bf16_f32 v99, v42, v43
    v_mfma_f32_32x32x16_bf16 v[16:31], v[112:115], a[208:211], v[16:31]
    ds_read_b128 v[112:115], v190 offset:6144
    v_exp_f32 v45, v45
    v_exp_f32 v46, v46
    s_waitcnt lgkmcnt(3)
    v_mfma_f32_32x32x16_bf16 v[0:15], v[116:119], a[176:179], v[0:15]
    v_cvt_pk_bf16_f32 v102, v44, v45
    v_exp_f32 v47, v47
    v_permlane16_swap_b32 v96, v100
    v_cvt_pk_bf16_f32 v103, v46, v47
    v_permlane16_swap_b32 v97, v101
    v_mfma_f32_32x32x16_bf16 v[16:31], v[116:119], a[212:215], v[16:31]
    ds_read_b128 v[116:119], v191 offset:7168
    v_permlane16_swap_b32 v98, v102
    v_permlane16_swap_b32 v99, v103
    v_exp_f32 v48, v48
    s_waitcnt lgkmcnt(2)
    v_mfma_f32_32x32x16_bf16 v[0:15], v[120:123], a[180:183], v[0:15]
    v_exp_f32 v49, v49
    v_exp_f32 v50, v50
    v_cvt_pk_bf16_f32 v104, v48, v49
    v_mfma_f32_32x32x16_bf16 v[16:31], v[120:123], a[216:219], v[16:31]
    ds_read_b128 v[120:123], v190 offset:8192
    v_exp_f32 v51, v51
    v_exp_f32 v52, v52
    s_waitcnt lgkmcnt(2)
    v_mfma_f32_32x32x16_bf16 v[0:15], v[112:115], a[184:187], v[0:15]
    v_cvt_pk_bf16_f32 v105, v50, v51
    v_exp_f32 v53, v53
    v_exp_f32 v54, v54
    v_cvt_pk_bf16_f32 v108, v52, v53
    v_mfma_f32_32x32x16_bf16 v[16:31], v[112:115], a[220:223], v[16:31]
    v_exp_f32 v55, v55
    v_exp_f32 v56, v56
    v_cvt_pk_bf16_f32 v109, v54, v55
    s_waitcnt lgkmcnt(1)
    v_mfma_f32_32x32x16_bf16 v[0:15], v[116:119], a[188:191], v[0:15]
    v_exp_f32 v57, v57
    v_exp_f32 v58, v58
    v_cvt_pk_bf16_f32 v106, v56, v57
    v_mfma_f32_32x32x16_bf16 v[16:31], v[116:119], a[224:227], v[16:31]
    v_exp_f32 v59, v59
    v_exp_f32 v60, v60
    v_cvt_pk_bf16_f32 v107, v58, v59
    s_waitcnt lgkmcnt(0)
    v_mfma_f32_32x32x16_bf16 v[0:15], v[120:123], a[192:195], v[0:15]
    v_exp_f32 v61, v61
    v_exp_f32 v62, v62
    v_cvt_pk_bf16_f32 v110, v60, v61
    v_mfma_f32_32x32x16_bf16 v[16:31], v[120:123], a[228:231], v[16:31]
    v_exp_f32 v63, v63
    v_permlane16_swap_b32 v104, v108
    v_cvt_pk_bf16_f32 v111, v62, v63
    v_permlane16_swap_b32 v105, v109
    v_permlane16_swap_b32 v106, v110
    v_mfma_f32_16x16x32_bf16 a[0:3], v[124:127], v[96:99], a[0:3]
    s_add_u32 m0, s13, 73728
    v_permlane16_swap_b32 v107, v111
    v_mfma_f32_16x16x32_bf16 a[4:7], v[124:127], v[100:103], a[4:7]
    buffer_load_dwordx4 v206, s[4:7], s12 offen offset:0 sc1 lds
    v_mfma_f32_16x16x32_bf16 a[8:11], v[128:131], v[96:99], a[8:11]
    v_mfma_f32_16x16x32_bf16 a[12:15], v[128:131], v[100:103], a[12:15]
    v_mfma_f32_16x16x32_bf16 a[16:19], v[132:135], v[96:99], a[16:19]
    buffer_load_dwordx4 v206, s[4:7], s12 offen offset:1024 sc1 lds
    v_mfma_f32_16x16x32_bf16 a[20:23], v[132:135], v[100:103], a[20:23]
    v_add_f32 v161, v161, v33
    v_add_f32 v160, v160, v34
    v_mfma_f32_16x16x32_bf16 a[24:27], v[136:139], v[96:99], a[24:27]
    v_add_f32 v161, v161, v35
    v_add_f32 v160, v160, v32
    v_mfma_f32_16x16x32_bf16 a[28:31], v[136:139], v[100:103], a[28:31]
    buffer_load_dwordx4 v206, s[4:7], s12 offen offset:2048 sc1 lds
    v_add_f32 v161, v161, v37
    v_mfma_f32_16x16x32_bf16 a[32:35], v[140:143], v[96:99], a[32:35]
    v_add_f32 v160, v160, v38
    v_add_f32 v160, v160, v36
    v_mfma_f32_16x16x32_bf16 a[36:39], v[140:143], v[100:103], a[36:39]
    v_add_f32 v161, v161, v39
    v_add_f32 v160, v160, v40
    v_mfma_f32_16x16x32_bf16 a[40:43], v[144:147], v[96:99], a[40:43]
    buffer_load_dwordx4 v206, s[4:7], s12 offen offset:3072 sc1 lds
    v_add_f32 v160, v160, v42
    v_mfma_f32_16x16x32_bf16 a[44:47], v[144:147], v[100:103], a[44:47]
    v_add_f32 v160, v160, v44
    v_add_f32 v161, v161, v41
    v_mfma_f32_16x16x32_bf16 a[48:51], v[148:151], v[96:99], a[48:51]
    s_add_u32 m0, s13, 77824
    v_add_f32 v161, v161, v43
    v_mfma_f32_16x16x32_bf16 a[52:55], v[148:151], v[100:103], a[52:55]
    buffer_load_dwordx4 v207, s[4:7], s12 offen offset:0 sc1 lds
    v_add_f32 v160, v160, v46
    v_mfma_f32_16x16x32_bf16 a[56:59], v[152:155], v[96:99], a[56:59]
    v_add_f32 v161, v161, v47
    v_add_f32 v161, v161, v45
    v_mfma_f32_16x16x32_bf16 a[60:63], v[152:155], v[100:103], a[60:63]
    v_add_f32 v162, v162, v50
    v_add_f32 v162, v162, v48
    v_mfma_f32_16x16x32_bf16 a[64:67], v[156:159], v[96:99], a[64:67]
    buffer_load_dwordx4 v207, s[4:7], s12 offen offset:1024 sc1 lds
    v_add_f32 v163, v163, v49
    v_mfma_f32_16x16x32_bf16 a[68:71], v[156:159], v[100:103], a[68:71]
    v_add_f32 v163, v163, v51
    v_add_f32 v162, v162, v52
    v_mfma_f32_16x16x32_bf16 a[80:83], v[124:127], v[104:107], a[80:83]
    v_add_f32 v163, v163, v53
    v_add_f32 v162, v162, v54
    v_mfma_f32_16x16x32_bf16 a[84:87], v[124:127], v[108:111], a[84:87]
    buffer_load_dwordx4 v207, s[4:7], s12 offen offset:2048 sc1 lds
    v_add_f32 v162, v162, v56
    v_mfma_f32_16x16x32_bf16 a[88:91], v[128:131], v[104:107], a[88:91]
    ds_read_b64_tr_b16 v[124:125], v194 offset:0
    v_add_f32 v163, v163, v55
    v_mfma_f32_16x16x32_bf16 a[92:95], v[128:131], v[108:111], a[92:95]
    ds_read_b64_tr_b16 v[126:127], v194 offset:256
    buffer_load_dwordx4 v207, s[4:7], s12 offen offset:3072 sc1 lds
    v_mfma_f32_16x16x32_bf16 a[96:99], v[132:135], v[104:107], a[96:99]
    ds_read_b64_tr_b16 v[128:129], v195 offset:1024
    s_add_u32 m0, s13, 81920
    v_mfma_f32_16x16x32_bf16 a[100:103], v[132:135], v[108:111], a[100:103]
    ds_read_b64_tr_b16 v[130:131], v195 offset:1280
    buffer_load_dwordx4 v208, s[4:7], s12 offen offset:0 sc1 lds
    v_mfma_f32_16x16x32_bf16 a[104:107], v[136:139], v[104:107], a[104:107]
    ds_read_b64_tr_b16 v[132:133], v194 offset:2048
    s_add_u32 s12, s12, 9216
    v_mfma_f32_16x16x32_bf16 a[108:111], v[136:139], v[108:111], a[108:111]
    ds_read_b64_tr_b16 v[134:135], v194 offset:2304
    v_add_f32 v162, v162, v58
    v_mfma_f32_16x16x32_bf16 a[112:115], v[140:143], v[104:107], a[112:115]
    ds_read_b64_tr_b16 v[136:137], v195 offset:3072
    v_add_f32 v163, v163, v57
    v_mfma_f32_16x16x32_bf16 a[116:119], v[140:143], v[108:111], a[116:119]
    s_waitcnt vmcnt(9)
    ds_read_b128 v[112:115], v190 offset:36864
    ds_read_b64_tr_b16 v[138:139], v195 offset:3328
    v_mfma_f32_16x16x32_bf16 a[120:123], v[144:147], v[104:107], a[120:123]
    ds_read_b64_tr_b16 v[140:141], v194 offset:4096
    v_add_f32 v162, v162, v60
    v_mfma_f32_16x16x32_bf16 a[124:127], v[144:147], v[108:111], a[124:127]
    ds_read_b128 v[116:119], v191 offset:37888
    ds_read_b64_tr_b16 v[142:143], v194 offset:4352
    v_mfma_f32_16x16x32_bf16 a[128:131], v[148:151], v[104:107], a[128:131]
    ds_read_b64_tr_b16 v[144:145], v195 offset:5120
    v_add_f32 v163, v163, v59
    v_mfma_f32_16x16x32_bf16 a[132:135], v[148:151], v[108:111], a[132:135]
    ds_read_b128 v[120:123], v190 offset:38912
    ds_read_b64_tr_b16 v[146:147], v195 offset:5376
    v_mfma_f32_16x16x32_bf16 a[136:139], v[152:155], v[104:107], a[136:139]
    ds_read_b64_tr_b16 v[148:149], v194 offset:6144
    v_add_f32 v162, v162, v62
    v_mfma_f32_16x16x32_bf16 a[140:143], v[152:155], v[108:111], a[140:143]
    ds_read_b64_tr_b16 v[150:151], v194 offset:6400
    v_add_f32 v163, v163, v61
    v_mfma_f32_16x16x32_bf16 a[144:147], v[156:159], v[104:107], a[144:147]
    ds_read_b64_tr_b16 v[152:153], v195 offset:7168
    v_add_f32 v163, v163, v63
    v_mfma_f32_16x16x32_bf16 a[148:151], v[156:159], v[108:111], a[148:151]
    ds_read_b64_tr_b16 v[154:155], v195 offset:7424
    s_sub_u32 s14, s14, 1
    s_mov_b32 s30, 0
    s_cmp_eq_u32 s14, 2
    s_cselect_b32 s26, 0x10000000, 0
    s_cmp_eq_u32 s14, 1
    s_cbranch_scc0 Lk_loop
    s_cmp_eq_u32 s59, 1
    s_cbranch_scc1 Lk_loop
    s_mov_b32 s68, 0
Lk_chk:
    v_cmp_eq_u32 vcc, s20, v210
    s_nop 1
    s_cmp_eq_u64 vcc, -1
    s_cbranch_scc1 Lk_loop
    s_sleep 1
    buffer_load_dword v210, v216, s[4:7], 0 offen sc1
    s_waitcnt vmcnt(0)
    s_add_u32 s68, s68, 1
    s_cmp_lt_u32 s68, 200000
    s_cbranch_scc1 Lk_chk
    s_branch Lk_loop
Lk_last:
    v_exp_f32 v48, v48
    ds_read_b64_tr_b16 v[156:157], v196 offset:45056
    v_exp_f32 v49, v49
    ds_read_b64_tr_b16 v[158:159], v196 offset:45312
    v_exp_f32 v50, v50
    v_cvt_pk_bf16_f32 v104, v48, v49
    v_exp_f32 v51, v51
    v_exp_f32 v52, v52
    v_cvt_pk_bf16_f32 v105, v50, v51
    v_exp_f32 v53, v53
    v_exp_f32 v54, v54
    v_cvt_pk_bf16_f32 v108, v52, v53
    v_exp_f32 v55, v55
    v_exp_f32 v56, v56
    v_cvt_pk_bf16_f32 v109, v54, v55
    v_exp_f32 v57, v57
    v_exp_f32 v58, v58
    v_cvt_pk_bf16_f32 v106, v56, v57
    v_exp_f32 v59, v59
    v_exp_f32 v60, v60
    v_cvt_pk_bf16_f32 v107, v58, v59
    v_exp_f32 v61, v61
    v_exp_f32 v62, v62
    v_cvt_pk_bf16_f32 v110, v60, v61
    v_exp_f32 v63, v63
    s_nop 0
    v_cvt_pk_bf16_f32 v111, v62, v63
    v_permlane16_swap_b32 v104, v108
    v_permlane16_swap_b32 v105, v109
    v_permlane16_swap_b32 v106, v110
    v_permlane16_swap_b32 v107, v111
    s_waitcnt lgkmcnt(2)
    s_nop 0
    v_mfma_f32_16x16x32_bf16 a[80:83], v[124:127], v[104:107], a[80:83]
    v_lshlrev_b32 v223, 3, v220
    v_add_u32 v223, s13, v223
    v_mfma_f32_16x16x32_bf16 a[84:87], v[124:127], v[108:111], a[84:87]
    v_add_u32 v223, 110592, v223
    v_mfma_f32_16x16x32_bf16 a[88:91], v[128:131], v[104:107], a[88:91]
    v_exp_f32 v32, v32
    v_mfma_f32_16x16x32_bf16 a[92:95], v[128:131], v[108:111], a[92:95]
    v_exp_f32 v33, v33
    v_mfma_f32_16x16x32_bf16 a[96:99], v[132:135], v[104:107], a[96:99]
    v_exp_f32 v34, v34
    v_mfma_f32_16x16x32_bf16 a[100:103], v[132:135], v[108:111], a[100:103]
    v_cvt_pk_bf16_f32 v96, v32, v33
    v_mfma_f32_16x16x32_bf16 a[104:107], v[136:139], v[104:107], a[104:107]
    v_exp_f32 v35, v35
    v_mfma_f32_16x16x32_bf16 a[108:111], v[136:139], v[108:111], a[108:111]
    v_exp_f32 v36, v36
    v_mfma_f32_16x16x32_bf16 a[112:115], v[140:143], v[104:107], a[112:115]
    v_cvt_pk_bf16_f32 v97, v34, v35
    v_mfma_f32_16x16x32_bf16 a[116:119], v[140:143], v[108:111], a[116:119]
    v_exp_f32 v37, v37
    v_mfma_f32_16x16x32_bf16 a[120:123], v[144:147], v[104:107], a[120:123]
    v_exp_f32 v38, v38
    v_mfma_f32_16x16x32_bf16 a[124:127], v[144:147], v[108:111], a[124:127]
    v_cvt_pk_bf16_f32 v100, v36, v37
    v_mfma_f32_16x16x32_bf16 a[128:131], v[148:151], v[104:107], a[128:131]
    v_exp_f32 v39, v39
    v_mfma_f32_16x16x32_bf16 a[132:135], v[148:151], v[108:111], a[132:135]
    v_exp_f32 v40, v40
    v_mfma_f32_16x16x32_bf16 a[136:139], v[152:155], v[104:107], a[136:139]
    v_cvt_pk_bf16_f32 v101, v38, v39
    v_mfma_f32_16x16x32_bf16 a[140:143], v[152:155], v[108:111], a[140:143]
    v_exp_f32 v41, v41
    s_waitcnt lgkmcnt(0)
    v_mfma_f32_16x16x32_bf16 a[144:147], v[156:159], v[104:107], a[144:147]
    v_exp_f32 v42, v42
    v_mfma_f32_16x16x32_bf16 a[148:151], v[156:159], v[108:111], a[148:151]
    v_cvt_pk_bf16_f32 v98, v40, v41
    v_exp_f32 v43, v43
    v_exp_f32 v44, v44
    v_cvt_pk_bf16_f32 v99, v42, v43
    v_exp_f32 v45, v45
    v_exp_f32 v46, v46
    v_cvt_pk_bf16_f32 v102, v44, v45
    v_exp_f32 v47, v47
    s_nop 0
    v_cvt_pk_bf16_f32 v103, v46, v47
    v_permlane16_swap_b32 v96, v100
    v_permlane16_swap_b32 v97, v101
    v_permlane16_swap_b32 v98, v102
    v_permlane16_swap_b32 v99, v103
    v_add_f32 v162, v162, v48
    v_add_f32 v163, v163, v49
    v_add_f32 v162, v162, v50
    v_add_f32 v163, v163, v51
    v_add_f32 v162, v162, v52
    v_add_f32 v163, v163, v53
    v_add_f32 v162, v162, v54
    v_add_f32 v163, v163, v55
    v_add_f32 v162, v162, v56
    v_add_f32 v163, v163, v57
    v_add_f32 v162, v162, v58
    v_add_f32 v163, v163, v59
    v_add_f32 v162, v162, v60
    v_add_f32 v163, v163, v61
    v_add_f32 v162, v162, v62
    v_add_f32 v163, v163, v63
    v_mfma_f32_16x16x32_bf16 a[0:3], v[124:127], v[96:99], a[0:3]
    v_add_f32 v160, v160, v32
    v_add_f32 v161, v161, v33
    v_add_f32 v160, v160, v34
    v_mfma_f32_16x16x32_bf16 a[4:7], v[124:127], v[100:103], a[4:7]
    v_add_f32 v161, v161, v35
    v_add_f32 v160, v160, v36
    v_add_f32 v161, v161, v37
    v_mfma_f32_16x16x32_bf16 a[8:11], v[128:131], v[96:99], a[8:11]
    v_add_f32 v160, v160, v38
    v_add_f32 v161, v161, v39
    v_add_f32 v160, v160, v40
    v_mfma_f32_16x16x32_bf16 a[12:15], v[128:131], v[100:103], a[12:15]
    v_add_f32 v161, v161, v41
    v_add_f32 v160, v160, v42
    v_add_f32 v161, v161, v43
    v_mfma_f32_16x16x32_bf16 a[16:19], v[132:135], v[96:99], a[16:19]
    v_add_f32 v160, v160, v44
    v_add_f32 v161, v161, v45
    v_add_f32 v160, v160, v46
    v_mfma_f32_16x16x32_bf16 a[20:23], v[132:135], v[100:103], a[20:23]
    v_add_f32 v161, v161, v47
    v_accvgpr_read_b32 v8, a80
    v_accvgpr_read_b32 v9, a81
    v_mfma_f32_16x16x32_bf16 a[24:27], v[136:139], v[96:99], a[24:27]
    v_accvgpr_read_b32 v10, a82
    v_accvgpr_read_b32 v11, a83
    v_cvt_pk_bf16_f32 v8, v8, v9
    v_mfma_f32_16x16x32_bf16 a[28:31], v[136:139], v[100:103], a[28:31]
    v_cvt_pk_bf16_f32 v9, v10, v11
    ds_write_b64 v223, v[8:9] offset:0
    v_accvgpr_read_b32 v12, a84
    v_mfma_f32_16x16x32_bf16 a[32:35], v[140:143], v[96:99], a[32:35]
    v_accvgpr_read_b32 v13, a85
    v_accvgpr_read_b32 v14, a86
    v_accvgpr_read_b32 v15, a87
    v_mfma_f32_16x16x32_bf16 a[36:39], v[140:143], v[100:103], a[36:39]
    v_cvt_pk_bf16_f32 v12, v12, v13
    v_cvt_pk_bf16_f32 v13, v14, v15
    ds_write_b64 v223, v[12:13] offset:512
    v_mfma_f32_16x16x32_bf16 a[40:43], v[144:147], v[96:99], a[40:43]
    v_accvgpr_read_b32 v16, a88
    v_accvgpr_read_b32 v17, a89
    v_accvgpr_read_b32 v18, a90
    v_mfma_f32_16x16x32_bf16 a[44:47], v[144:147], v[100:103], a[44:47]
    v_accvgpr_read_b32 v19, a91
    v_cvt_pk_bf16_f32 v16, v16, v17
    v_cvt_pk_bf16_f32 v17, v18, v19
    v_mfma_f32_16x16x32_bf16 a[48:51], v[148:151], v[96:99], a[48:51]
    ds_write_b64 v223, v[16:17] offset:1024
    v_accvgpr_read_b32 v20, a92
    v_accvgpr_read_b32 v21, a93
    v_mfma_f32_16x16x32_bf16 a[52:55], v[148:151], v[100:103], a[52:55]
    v_accvgpr_read_b32 v22, a94
    v_accvgpr_read_b32 v23, a95
    v_cvt_pk_bf16_f32 v20, v20, v21
    v_mfma_f32_16x16x32_bf16 a[56:59], v[152:155], v[96:99], a[56:59]
    v_cvt_pk_bf16_f32 v21, v22, v23
    ds_write_b64 v223, v[20:21] offset:1536
    v_accvgpr_read_b32 v8, a96
    v_mfma_f32_16x16x32_bf16 a[60:63], v[152:155], v[100:103], a[60:63]
    v_accvgpr_read_b32 v9, a97
    v_accvgpr_read_b32 v10, a98
    v_accvgpr_read_b32 v11, a99
    v_mfma_f32_16x16x32_bf16 a[64:67], v[156:159], v[96:99], a[64:67]
    v_cvt_pk_bf16_f32 v8, v8, v9
    v_cvt_pk_bf16_f32 v9, v10, v11
    ds_write_b64 v223, v[8:9] offset:2048
    v_mfma_f32_16x16x32_bf16 a[68:71], v[156:159], v[100:103], a[68:71]
    v_accvgpr_read_b32 v12, a100
    v_accvgpr_read_b32 v13, a101
    v_accvgpr_read_b32 v14, a102
    v_accvgpr_read_b32 v15, a103
    v_cvt_pk_bf16_f32 v12, v12, v13
    v_cvt_pk_bf16_f32 v13, v14, v15
    ds_write_b64 v223, v[12:13] offset:2560
    v_accvgpr_read_b32 v16, a104
    v_accvgpr_read_b32 v17, a105
    v_accvgpr_read_b32 v18, a106
    v_accvgpr_read_b32 v19, a107
    v_cvt_pk_bf16_f32 v16, v16, v17
    v_cvt_pk_bf16_f32 v17, v18, v19
    ds_write_b64 v223, v[16:17] offset:3072
    v_accvgpr_read_b32 v20, a108
    v_accvgpr_read_b32 v21, a109
    v_accvgpr_read_b32 v22, a110
    v_accvgpr_read_b32 v23, a111
    v_cvt_pk_bf16_f32 v20, v20, v21
    v_cvt_pk_bf16_f32 v21, v22, v23
    ds_write_b64 v223, v[20:21] offset:3584
    v_accvgpr_read_b32 v8, a112
    v_accvgpr_read_b32 v9, a113
    v_accvgpr_read_b32 v10, a114
    v_accvgpr_read_b32 v11, a115
    v_cvt_pk_bf16_f32 v8, v8, v9
    v_cvt_pk_bf16_f32 v9, v10, v11
    ds_write_b64 v223, v[8:9] offset:4096
    v_accvgpr_read_b32 v12, a116
    v_accvgpr_read_b32 v13, a117
    v_accvgpr_read_b32 v14, a118
    v_accvgpr_read_b32 v15, a119
    v_cvt_pk_bf16_f32 v12, v12, v13
    v_cvt_pk_bf16_f32 v13, v14, v15
    ds_write_b64 v223, v[12:13] offset:4608
    v_accvgpr_read_b32 v16, a120
    v_accvgpr_read_b32 v17, a121
    v_accvgpr_read_b32 v18, a122
    v_accvgpr_read_b32 v19, a123
    v_cvt_pk_bf16_f32 v16, v16, v17
    v_cvt_pk_bf16_f32 v17, v18, v19
    ds_write_b64 v223, v[16:17] offset:5120
    v_accvgpr_read_b32 v20, a124
    v_accvgpr_read_b32 v21, a125
    v_accvgpr_read_b32 v22, a126
    v_accvgpr_read_b32 v23, a127
    v_cvt_pk_bf16_f32 v20, v20, v21
    v_cvt_pk_bf16_f32 v21, v22, v23
    ds_write_b64 v223, v[20:21] offset:5632
    v_accvgpr_read_b32 v8, a128
    v_accvgpr_read_b32 v9, a129
    v_accvgpr_read_b32 v10, a130
    v_accvgpr_read_b32 v11, a131
    v_cvt_pk_bf16_f32 v8, v8, v9
    v_cvt_pk_bf16_f32 v9, v10, v11
    ds_write_b64 v223, v[8:9] offset:6144
    v_accvgpr_read_b32 v12, a132
    v_accvgpr_read_b32 v13, a133
    v_accvgpr_read_b32 v14, a134
    v_accvgpr_read_b32 v15, a135
    v_cvt_pk_bf16_f32 v12, v12, v13
    v_cvt_pk_bf16_f32 v13, v14, v15
    ds_write_b64 v223, v[12:13] offset:6656
    v_accvgpr_read_b32 v16, a136
    v_accvgpr_read_b32 v17, a137
    v_accvgpr_read_b32 v18, a138
    v_accvgpr_read_b32 v19, a139
    v_cvt_pk_bf16_f32 v16, v16, v17
    v_cvt_pk_bf16_f32 v17, v18, v19
    ds_write_b64 v223, v[16:17] offset:7168
    v_accvgpr_read_b32 v20, a140
    v_accvgpr_read_b32 v21, a141
    v_accvgpr_read_b32 v22, a142
    v_accvgpr_read_b32 v23, a143
    v_cvt_pk_bf16_f32 v20, v20, v21
    v_cvt_pk_bf16_f32 v21, v22, v23
    ds_write_b64 v223, v[20:21] offset:7680
    v_accvgpr_read_b32 v8, a144
    v_accvgpr_read_b32 v9, a145
    v_accvgpr_read_b32 v10, a146
    v_accvgpr_read_b32 v11, a147
    v_cvt_pk_bf16_f32 v8, v8, v9
    v_cvt_pk_bf16_f32 v9, v10, v11
    ds_write_b64 v223, v[8:9] offset:8192
    v_accvgpr_read_b32 v12, a148
    v_accvgpr_read_b32 v13, a149
    v_accvgpr_read_b32 v14, a150
    v_accvgpr_read_b32 v15, a151
    v_cvt_pk_bf16_f32 v12, v12, v13
    v_cvt_pk_bf16_f32 v13, v14, v15
    ds_write_b64 v223, v[12:13] offset:8704
    v_add_f32 v24, v162, v163
    v_add_f32 v26, v160, v161
    v_mov_b32 v25, v24
    v_mov_b32 v27, v26
    v_lshlrev_b32 v226, 4, v220
    s_lshl_b32 s60, s16, 2
    v_permlane32_swap_b32 v24, v25
    v_permlane32_swap_b32 v26, v27
    s_add_u32 s60, s60, 147456
    v_add_f32 v24, v24, v25
    v_add_f32 v26, v26, v27
    v_mov_b32 v25, v24
    v_mov_b32 v27, v26
    v_add_u32 v28, s60, v226
    v_add_u32 v226, 147456, v226
    v_permlane16_swap_b32 v24, v25
    v_permlane16_swap_b32 v26, v27
    ds_write_b32 v28, v24
    ds_write_b32 v28, v25 offset:1024
    ds_write_b32 v28, v26 offset:2048
    ds_write_b32 v28, v27 offset:3072
    s_lshl_b32 s60, s16, 9
    s_add_u32 s60, s60, 110592
    v_lshlrev_b32 v225, 3, v220
    v_add_u32 v225, s60, v225
    v_lshlrev_b32 v224, 4, v220
    s_waitcnt vmcnt(0) lgkmcnt(0)
    s_barrier
    ds_read_b64 v[0:1], v225 offset:0
    ds_read_b64 v[2:3], v225 offset:9216
    ds_read_b64 v[4:5], v225 offset:18432
    ds_read_b64 v[6:7], v225 offset:27648
    ds_read_b64 v[8:9], v225 offset:2048
    ds_read_b64 v[10:11], v225 offset:11264
    ds_read_b64 v[12:13], v225 offset:20480
    ds_read_b64 v[14:15], v225 offset:29696
    ds_read_b64 v[16:17], v225 offset:4096
    ds_read_b64 v[18:19], v225 offset:13312
    ds_read_b64 v[20:21], v225 offset:22528
    ds_read_b64 v[22:23], v225 offset:31744
    ds_read_b64 v[24:25], v225 offset:6144
    ds_read_b64 v[26:27], v225 offset:15360
    ds_read_b64 v[28:29], v225 offset:24576
    ds_read_b64 v[30:31], v225 offset:33792
    ds_read_b64 v[32:33], v225 offset:8192
    ds_read_b64 v[34:35], v225 offset:17408
    ds_read_b64 v[36:37], v225 offset:26624
    ds_read_b64 v[38:39], v225 offset:35840
    s_and_b32 s66, s16, 1
    s_lshl_b32 s66, s66, 10
    v_add_u32 v40, s66, v226
    s_xor_b32 s66, s66, 1024
    v_add_u32 v41, s66, v226
    ds_read_b128 v[144:147], v40 offset:0
    ds_read_b128 v[148:151], v41 offset:0
    ds_read_b128 v[152:155], v40 offset:2048
    ds_read_b128 v[156:159], v41 offset:2048
    v_bfe_u32 v126, v220, 2, 2
    v_and_b32 v127, 3, v220
    v_lshrrev_b32 v128, 4, v220
    v_mul_u32_u24 v129, 288, v126
    v_lshl_add_u32 v129, v127, 3, v129
    s_lshl_b32 s60, s16, 6
    v_add_u32 v218, s60, v129
    v_mul_u32_u24 v130, 2304, v128
    v_add_u32 v216, v218, v130
    v_add_u32 v218, 151552, v218
    v_add_u32 v219, 151808, v129
    s_mul_i32 s60, s16, 2304
    v_mul_u32_u24 v130, 576, v128
    v_add3_u32 v217, v129, v130, s60
    s_xor_b32 s60, s2, 1
    s_mul_i32 s60, s60, 28672
    s_mul_i32 s61, s16, 4096
    s_add_u32 s60, s60, s61
    s_add_u32 s60, s60, 12582912
    v_mov_b32 v71, s20
    v_mov_b32 v75, s20
    v_mov_b32 v79, s20
    v_mov_b32 v83, s20
    s_waitcnt lgkmcnt(0)
    v_mfma_f32_16x16x32_bf16 v[48:51], v[182:185], v[0:3], 0
    v_add_f32 v144, v144, v145
    v_add_f32 v146, v146, v147
    v_add_f32 v81, v144, v146
    v_mfma_f32_16x16x32_bf16 v[52:55], v[182:185], v[8:11], 0
    v_add_f32 v148, v148, v149
    v_add_f32 v150, v150, v151
    v_add_f32 v82, v148, v150
    v_mfma_f32_16x16x32_bf16 v[56:59], v[182:185], v[16:19], 0
    v_add_f32 v152, v152, v153
    v_add_f32 v154, v154, v155
    v_add_f32 v140, v152, v154
    v_mfma_f32_16x16x32_bf16 v[60:63], v[182:185], v[24:27], 0
    v_add_f32 v156, v156, v157
    v_add_f32 v158, v158, v159
    v_add_f32 v141, v156, v158
    ds_read_b64_tr_b16 v[186:187], v218 offset:0
    ds_read_b64_tr_b16 v[194:195], v218 offset:32
    v_mfma_f32_16x16x32_bf16 v[64:67], v[182:185], v[32:35], 0
    ds_read_b64_tr_b16 v[202:203], v219 offset:0
    ds_read_b64_tr_b16 v[188:189], v218 offset:1152
    v_mfma_f32_16x16x32_bf16 v[48:51], v[182:185], v[4:7], v[48:51]
    ds_read_b64_tr_b16 v[196:197], v218 offset:1184
    ds_read_b64_tr_b16 v[204:205], v219 offset:1152
    v_mfma_f32_16x16x32_bf16 v[52:55], v[182:185], v[12:15], v[52:55]
    ds_read_b64_tr_b16 v[190:191], v218 offset:2304
    ds_read_b64_tr_b16 v[198:199], v218 offset:2336
    v_mfma_f32_16x16x32_bf16 v[56:59], v[182:185], v[20:23], v[56:59]
    ds_read_b64_tr_b16 v[206:207], v219 offset:2304
    ds_read_b64_tr_b16 v[192:193], v218 offset:3456
    v_mfma_f32_16x16x32_bf16 v[60:63], v[182:185], v[28:31], v[60:63]
    ds_read_b64_tr_b16 v[200:201], v218 offset:3488
    ds_read_b64_tr_b16 v[208:209], v219 offset:3456
    v_mfma_f32_16x16x32_bf16 v[64:67], v[182:185], v[36:39], v[64:67]
    ds_read_b64_tr_b16 v[84:85], v216 offset:9216
    ds_read_b64_tr_b16 v[96:97], v216 offset:9248
    s_mov_b32 s32, s4
    s_mov_b32 s33, s5
    s_cmp_eq_u32 s59, 0
    s_cselect_b32 s34, 0x10000000, 0
    s_mov_b32 s35, 0x00020000
    v_cvt_pk_bf16_f32 v68, v48, v49
    ds_read_b64_tr_b16 v[86:87], v216 offset:10368
    v_cvt_pk_bf16_f32 v69, v50, v51
    ds_read_b64_tr_b16 v[98:99], v216 offset:10400
    v_cvt_pk_bf16_f32 v70, v52, v53
    ds_read_b64_tr_b16 v[88:89], v216 offset:11520
    v_cvt_pk_bf16_f32 v74, v54, v55
    ds_read_b64_tr_b16 v[100:101], v216 offset:11552
    buffer_store_dwordx4 v[68:71], v224, s[32:35], s60 offen sc1
    v_cvt_pk_bf16_f32 v72, v56, v57
    ds_read_b64_tr_b16 v[90:91], v216 offset:12672
    v_cvt_pk_bf16_f32 v73, v58, v59
    ds_read_b64_tr_b16 v[102:103], v216 offset:12704
    buffer_store_dwordx4 v[72:75], v224, s[32:35], s60 offen offset:1024 sc1
    v_cvt_pk_bf16_f32 v76, v60, v61
    ds_read_b64_tr_b16 v[92:93], v216 offset:13824
    v_cvt_pk_bf16_f32 v77, v62, v63
    ds_read_b64_tr_b16 v[104:105], v216 offset:13856
    v_cvt_pk_bf16_f32 v78, v64, v65
    ds_read_b64_tr_b16 v[94:95], v216 offset:14976
    v_cvt_pk_bf16_f32 v80, v66, v67
    ds_read_b64_tr_b16 v[106:107], v216 offset:15008
    buffer_store_dwordx4 v[76:79], v224, s[32:35], s60 offen offset:2048 sc1
    buffer_store_dwordx4 v[80:83], v224, s[32:35], s60 offen offset:3072 sc1
    ds_read_b64_tr_b16 v[108:109], v217 offset:9472
    ds_read_b64_tr_b16 v[110:111], v217 offset:10624
    ds_read_b64_tr_b16 v[112:113], v217 offset:11776
    ds_read_b64_tr_b16 v[114:115], v217 offset:12928
    ds_read_b64_tr_b16 v[116:117], v216 offset:0
    ds_read_b64_tr_b16 v[120:121], v216 offset:32
    ds_read_b64_tr_b16 v[118:119], v216 offset:1152
    ds_read_b64_tr_b16 v[122:123], v216 offset:1184
    ds_read_b64_tr_b16 v[124:125], v217 offset:256
    s_cmp_eq_u32 s83, 0
    s_cbranch_scc1 Lt_exit
    s_mul_i32 s60, s16, 18432
    s_add_u32 s60, s60, 73728
    v_add_u32 v210, s60, v224
    v_lshl_add_u32 v211, v126, 3, v127
    s_lshl_b32 s60, s16, 5
    v_add_u32 v211, s60, v211
    v_mul_u32_u24 v211, 80, v211
    v_lshl_add_u32 v211, v128, 4, v211
    v_and_b32 v212, 15, v220
    v_mul_u32_u24 v212, 80, v212
    v_lshl_add_u32 v212, v128, 2, v212
    s_lshl_b32 s60, s16, 4
    s_add_u32 s60, s60, 10240
    v_add_u32 v212, s60, v212
    s_mul_i32 s60, s16, 4608
    v_add_u32 v213, s60, v224
    v_lshlrev_b32 v225, 3, v220
    v_add_u32 v214, s60, v225
    s_mov_b32 s67, 0xffff0000
    s_mul_i32 s60, s2, 28672
    s_mul_i32 s61, s16, 4096
    s_add_u32 s60, s60, s61
    s_add_u32 s69, s60, 12582912
    s_mul_i32 s62, s16, 4608
    s_add_u32 s62, s62, 10354688
    s_waitcnt lgkmcnt(0)
    s_barrier
    v_and_b32 v193, 0xffff, v193
    v_lshlrev_b32 v230, 16, v186
    ds_read_b128 a[134:137], v213 offset:36864
    v_alignbit_b32 v231, v187, v186, 16
    ds_read_b128 a[138:141], v213 offset:37888
    v_alignbit_b32 v232, v188, v187, 16
    ds_read_b128 a[142:145], v213 offset:38912
    v_alignbit_b32 v233, v189, v188, 16
    ds_read_b128 a[146:149], v213 offset:39936
    v_alignbit_b32 v234, v190, v189, 16
    ds_read_b64 a[150:151], v214 offset:40960
    v_alignbit_b32 v235, v191, v190, 16
    ds_read_b128 a[196:199], v213 offset:55296
    s_add_u32 s63, s62, 0
    buffer_load_dwordx4 a[80:83], v224, s[4:7], s63 offen offset:0 sc1
    v_alignbit_b32 v236, v192, v191, 16
    ds_read_b128 a[200:203], v213 offset:56320
    v_alignbit_b32 v237, v193, v192, 16
    ds_read_b128 a[204:207], v213 offset:57344
    v_and_b32 v201, 0xffff, v201
    ds_read_b128 a[208:211], v213 offset:58368
    v_lshlrev_b32 v238, 16, v194
    ds_read_b64 a[212:213], v214 offset:59392
    v_alignbit_b32 v239, v195, v194, 16
    ds_read_b128 a[214:217], v224 offset:32256
    v_alignbit_b32 v240, v196, v195, 16
    ds_read_b128 a[218:221], v224 offset:33280
    v_alignbit_b32 v241, v197, v196, 16
    ds_read_b128 a[222:225], v224 offset:34304
    v_alignbit_b32 v242, v198, v197, 16
    ds_read_b128 a[226:229], v224 offset:35328
    v_alignbit_b32 v243, v199, v198, 16
    ds_read_b64 a[230:231], v225 offset:36352
    v_alignbit_b32 v244, v200, v199, 16
    ds_read_b128 a[116:119], v224 offset:27648
    v_alignbit_b32 v245, v201, v200, 16
    ds_read_b128 a[120:123], v224 offset:28672
    v_and_b32 v209, 0xffff, v209
    ds_read_b128 a[124:127], v224 offset:29696
    v_lshlrev_b32 v246, 16, v202
    ds_read_b128 a[128:131], v224 offset:30720
    buffer_load_dwordx4 a[84:87], v224, s[4:7], s63 offen offset:1024 sc1
    v_alignbit_b32 v247, v203, v202, 16
    ds_read_b64 a[132:133], v225 offset:31744
    v_alignbit_b32 v248, v204, v203, 16
    v_alignbit_b32 v249, v205, v204, 16
    v_alignbit_b32 v250, v206, v205, 16
    v_alignbit_b32 v251, v207, v206, 16
    ds_write_b128 v210, a[0:3] offset:0
    v_alignbit_b32 v252, v208, v207, 16
    v_alignbit_b32 v253, v209, v208, 16
    v_dot2_f32_bf16 v0, v84, v186, 0
    v_dot2_f32_bf16 v1, v84, v230, 0
    v_dot2_f32_bf16 v2, v85, v186, 0
    v_dot2_f32_bf16 v3, v85, v230, 0
    v_dot2_f32_bf16 v4, v86, v186, 0
    v_dot2_f32_bf16 v5, v86, v230, 0
    buffer_load_dwordx4 a[88:91], v224, s[4:7], s63 offen offset:2048 sc1
    v_dot2_f32_bf16 v6, v87, v186, 0
    ds_write_b128 v210, a[4:7] offset:1024
    v_dot2_f32_bf16 v7, v87, v230, 0
    v_dot2c_f32_bf16 v0, v85, v187
    v_dot2c_f32_bf16 v1, v85, v231
    v_dot2c_f32_bf16 v2, v86, v187
    v_dot2c_f32_bf16 v3, v86, v231
    v_dot2c_f32_bf16 v4, v87, v187
    v_dot2c_f32_bf16 v5, v87, v231
    v_dot2c_f32_bf16 v6, v88, v187
    v_dot2c_f32_bf16 v7, v88, v231
    ds_write_b128 v210, a[8:11] offset:2048
    v_dot2c_f32_bf16 v0, v86, v188
    v_dot2c_f32_bf16 v1, v86, v232
    v_dot2c_f32_bf16 v2, v87, v188
    buffer_load_dwordx4 a[92:95], v224, s[4:7], s63 offen offset:3072 sc1
    v_dot2c_f32_bf16 v3, v87, v232
    v_dot2c_f32_bf16 v4, v88, v188
    v_dot2c_f32_bf16 v5, v88, v232
    v_dot2c_f32_bf16 v6, v89, v188
    v_dot2c_f32_bf16 v7, v89, v232
    v_dot2c_f32_bf16 v0, v87, v189
    ds_write_b128 v210, a[12:15] offset:3072
    v_dot2c_f32_bf16 v1, v87, v233
    v_dot2c_f32_bf16 v2, v88, v189
    v_dot2c_f32_bf16 v3, v88, v233
    v_dot2c_f32_bf16 v4, v89, v189
    v_dot2c_f32_bf16 v5, v89, v233
    v_dot2c_f32_bf16 v6, v90, v189
    v_dot2c_f32_bf16 v7, v90, v233
    s_add_u32 s63, s63, 4096
    buffer_load_dwordx2 a[96:97], v225, s[4:7], s63 offen sc1
    v_dot2c_f32_bf16 v0, v88, v190
    v_dot2c_f32_bf16 v1, v88, v234
    ds_write_b128 v210, a[16:19] offset:4096
    v_dot2c_f32_bf16 v2, v89, v190
    v_dot2c_f32_bf16 v3, v89, v234
    v_dot2c_f32_bf16 v4, v90, v190
    v_dot2c_f32_bf16 v5, v90, v234
    v_dot2c_f32_bf16 v6, v91, v190
    v_dot2c_f32_bf16 v7, v91, v234
    v_dot2c_f32_bf16 v0, v89, v191
    v_dot2c_f32_bf16 v1, v89, v235
    v_dot2c_f32_bf16 v2, v90, v191
    ds_write_b128 v210, a[20:23] offset:5120
    v_dot2c_f32_bf16 v3, v90, v235
    v_dot2c_f32_bf16 v4, v91, v191
    s_add_u32 s63, s62, 18432
    buffer_load_dwordx4 a[98:101], v224, s[4:7], s63 offen offset:0 sc1
    v_dot2c_f32_bf16 v5, v91, v235
    v_dot2c_f32_bf16 v6, v92, v191
    v_dot2c_f32_bf16 v7, v92, v235
    v_dot2c_f32_bf16 v0, v90, v192
    v_dot2c_f32_bf16 v1, v90, v236
    v_dot2c_f32_bf16 v2, v91, v192
    v_dot2c_f32_bf16 v3, v91, v236
    ds_write_b128 v210, a[24:27] offset:6144
    v_dot2c_f32_bf16 v4, v92, v192
    v_dot2c_f32_bf16 v5, v92, v236
    v_dot2c_f32_bf16 v6, v93, v192
    v_dot2c_f32_bf16 v7, v93, v236
    v_dot2c_f32_bf16 v0, v91, v193
    v_dot2c_f32_bf16 v1, v91, v237
    buffer_load_dwordx4 a[102:105], v224, s[4:7], s63 offen offset:1024 sc1
    v_dot2c_f32_bf16 v2, v92, v193
    v_dot2c_f32_bf16 v3, v92, v237
    v_dot2c_f32_bf16 v4, v93, v193
    ds_write_b128 v210, a[28:31] offset:7168
    v_dot2c_f32_bf16 v5, v93, v237
    v_dot2c_f32_bf16 v6, v94, v193
    v_dot2c_f32_bf16 v7, v94, v237
    v_dot2_f32_bf16 v8, v96, v194, 0
    v_dot2_f32_bf16 v9, v96, v238, 0
    v_dot2_f32_bf16 v10, v97, v194, 0
    v_dot2_f32_bf16 v11, v97, v238, 0
    v_dot2_f32_bf16 v12, v98, v194, 0
    v_dot2_f32_bf16 v13, v98, v238, 0
    ds_write_b128 v210, a[32:35] offset:8192
    v_dot2_f32_bf16 v14, v99, v194, 0
    buffer_load_dwordx4 a[106:109], v224, s[4:7], s63 offen offset:2048 sc1
    v_dot2_f32_bf16 v15, v99, v238, 0
    v_dot2c_f32_bf16 v8, v97, v195
    v_dot2c_f32_bf16 v9, v97, v239
    v_dot2c_f32_bf16 v10, v98, v195
    v_dot2c_f32_bf16 v11, v98, v239
    v_dot2c_f32_bf16 v12, v99, v195
    v_dot2c_f32_bf16 v13, v99, v239
    v_dot2c_f32_bf16 v14, v100, v195
    ds_write_b128 v210, a[36:39] offset:9216
    v_dot2c_f32_bf16 v15, v100, v239
    v_dot2c_f32_bf16 v8, v98, v196
    v_dot2c_f32_bf16 v9, v98, v240
    v_dot2c_f32_bf16 v10, v99, v196
    v_dot2c_f32_bf16 v11, v99, v240
    buffer_load_dwordx4 a[110:113], v224, s[4:7], s63 offen offset:3072 sc1
    v_dot2c_f32_bf16 v12, v100, v196
    v_dot2c_f32_bf16 v13, v100, v240
    v_dot2c_f32_bf16 v14, v101, v196
    v_dot2c_f32_bf16 v15, v101, v240
    ds_write_b128 v210, a[40:43] offset:10240
    v_dot2c_f32_bf16 v8, v99, v197
    v_dot2c_f32_bf16 v9, v99, v241
    v_dot2c_f32_bf16 v10, v100, v197
    v_dot2c_f32_bf16 v11, v100, v241
    v_dot2c_f32_bf16 v12, v101, v197
    v_dot2c_f32_bf16 v13, v101, v241
    v_dot2c_f32_bf16 v14, v102, v197
    v_dot2c_f32_bf16 v15, v102, v241
    v_dot2c_f32_bf16 v8, v100, v198
    ds_write_b128 v210, a[44:47] offset:11264
    s_add_u32 s63, s63, 4096
    buffer_load_dwordx2 a[114:115], v225, s[4:7], s63 offen sc1
    v_dot2c_f32_bf16 v9, v100, v242
    v_dot2c_f32_bf16 v10, v101, v198
    v_dot2c_f32_bf16 v11, v101, v242
    v_dot2c_f32_bf16 v12, v102, v198
    v_dot2c_f32_bf16 v13, v102, v242
    v_dot2c_f32_bf16 v14, v103, v198
    v_dot2c_f32_bf16 v15, v103, v242
    v_dot2c_f32_bf16 v8, v101, v199
    v_dot2c_f32_bf16 v9, v101, v243
    ds_write_b128 v210, a[48:51] offset:12288
    v_dot2c_f32_bf16 v10, v102, v199
    v_dot2c_f32_bf16 v11, v102, v243
    v_dot2c_f32_bf16 v12, v103, v199
    v_dot2c_f32_bf16 v13, v103, v243
    buffer_load_dwordx4 v[32:35], v224, s[4:7], s69 offen offset:0 sc1
    v_dot2c_f32_bf16 v14, v104, v199
    v_dot2c_f32_bf16 v15, v104, v243
    v_dot2c_f32_bf16 v8, v102, v200
    v_dot2c_f32_bf16 v9, v102, v244
    v_dot2c_f32_bf16 v10, v103, v200
    ds_write_b128 v210, a[52:55] offset:13312
    v_dot2c_f32_bf16 v11, v103, v244
    v_dot2c_f32_bf16 v12, v104, v200
    v_dot2c_f32_bf16 v13, v104, v244
    v_dot2c_f32_bf16 v14, v105, v200
    v_dot2c_f32_bf16 v15, v105, v244
    v_dot2c_f32_bf16 v8, v103, v201
    v_dot2c_f32_bf16 v9, v103, v245
    v_dot2c_f32_bf16 v10, v104, v201
    buffer_load_dwordx4 v[36:39], v224, s[4:7], s69 offen offset:1024 sc1
    v_dot2c_f32_bf16 v11, v104, v245
    ds_write_b128 v210, a[56:59] offset:14336
    v_dot2c_f32_bf16 v12, v105, v201
    v_dot2c_f32_bf16 v13, v105, v245
    v_dot2c_f32_bf16 v14, v106, v201
    v_dot2c_f32_bf16 v15, v106, v245
    v_dot2_f32_bf16 v16, v108, v202, 0
    v_dot2_f32_bf16 v17, v108, v246, 0
    s_nop 1
    v_dot2c_f32_bf16 v16, v109, v203
    v_dot2c_f32_bf16 v17, v109, v247
    v_dot2c_f32_bf16 v16, v110, v204
    ds_write_b128 v210, a[60:63] offset:15360
    v_dot2c_f32_bf16 v17, v110, v248
    v_dot2c_f32_bf16 v16, v111, v205
    v_dot2c_f32_bf16 v17, v111, v249
    buffer_load_dwordx4 v[40:43], v224, s[4:7], s69 offen offset:2048 sc1
    v_dot2c_f32_bf16 v16, v112, v206
    v_dot2c_f32_bf16 v17, v112, v250
    v_dot2c_f32_bf16 v16, v113, v207
    v_dot2c_f32_bf16 v17, v113, v251
    v_dot2c_f32_bf16 v16, v114, v208
    v_dot2c_f32_bf16 v17, v114, v252
    ds_write_b128 v210, a[64:67] offset:16384
    v_dot2c_f32_bf16 v16, v115, v209
    v_dot2c_f32_bf16 v17, v115, v253
    v_lshlrev_b32 v18, 16, v116
    v_and_b32 v19, s67, v116
    v_mul_f32 v18, v18, v0
    v_mul_f32 v19, v19, v1
    v_cvt_pk_bf16_f32 v24, v18, v19
    buffer_load_dwordx4 v[44:47], v224, s[4:7], s69 offen offset:3072 sc1
    v_lshlrev_b32 v18, 16, v117
    v_and_b32 v19, s67, v117
    ds_write_b128 v210, a[68:71] offset:17408
    v_mul_f32 v18, v18, v2
    v_mul_f32 v19, v19, v3
    v_cvt_pk_bf16_f32 v25, v18, v19
    v_lshlrev_b32 v18, 16, v118
    v_and_b32 v19, s67, v118
    v_mul_f32 v18, v18, v4
    v_mul_f32 v19, v19, v5
    v_cvt_pk_bf16_f32 v26, v18, v19
    v_lshlrev_b32 v18, 16, v119
    v_and_b32 v19, s67, v119
    v_mul_f32 v18, v18, v6
    v_mul_f32 v19, v19, v7
    v_cvt_pk_bf16_f32 v27, v18, v19
    v_lshlrev_b32 v18, 16, v120
    v_and_b32 v19, s67, v120
    v_mul_f32 v18, v18, v8
    v_mul_f32 v19, v19, v9
    v_cvt_pk_bf16_f32 v28, v18, v19
    v_lshlrev_b32 v18, 16, v121
    v_and_b32 v19, s67, v121
    v_mul_f32 v18, v18, v10
    v_mul_f32 v19, v19, v11
    v_cvt_pk_bf16_f32 v29, v18, v19
    v_lshlrev_b32 v18, 16, v122
    v_and_b32 v19, s67, v122
    v_mul_f32 v18, v18, v12
    v_mul_f32 v19, v19, v13
    v_cvt_pk_bf16_f32 v30, v18, v19
    v_lshlrev_b32 v18, 16, v123
    v_and_b32 v19, s67, v123
    v_mul_f32 v18, v18, v14
    v_mul_f32 v19, v19, v15
    v_cvt_pk_bf16_f32 v31, v18, v19
    v_lshlrev_b32 v18, 16, v124
    v_and_b32 v19, s67, v124
    v_mul_f32 v18, v18, v16
    v_mul_f32 v19, v19, v17
    v_cvt_pk_bf16_f32 v22, v18, v19
    ds_write_b128 v211, v[24:27] offset:0
    ds_write_b128 v211, v[28:31] offset:320
    ds_write_b32 v212, v22 offset:0
    v_accvgpr_read_b32 v144, a232
    v_accvgpr_read_b32 v145, a233
    v_accvgpr_read_b32 v146, a234
    v_accvgpr_read_b32 v147, a235
    v_accvgpr_read_b32 v148, a236
    v_accvgpr_read_b32 v149, a237
    v_accvgpr_read_b32 v150, a238
    v_accvgpr_read_b32 v151, a239
    v_accvgpr_read_b32 v152, a240
    v_accvgpr_read_b32 v153, a241
    v_lshlrev_b32 v0, 16, v144
    v_and_b32 v1, s67, v144
    v_lshlrev_b32 v2, 16, v145
    v_and_b32 v3, s67, v145
    v_lshlrev_b32 v4, 16, v146
    v_and_b32 v5, s67, v146
    v_lshlrev_b32 v6, 16, v147
    v_and_b32 v7, s67, v147
    v_lshlrev_b32 v8, 16, v148
    v_and_b32 v9, s67, v148
    v_lshlrev_b32 v10, 16, v149
    v_and_b32 v11, s67, v149
    v_lshlrev_b32 v12, 16, v150
    v_and_b32 v13, s67, v150
    v_lshlrev_b32 v14, 16, v151
    v_and_b32 v15, s67, v151
    v_lshlrev_b32 v16, 16, v152
    v_and_b32 v17, s67, v152
    v_lshlrev_b32 v18, 16, v153
    v_and_b32 v19, s67, v153
    v_lshl_add_u32 v20, v128, 3, v126
    v_mul_u32_u24 v20, 80, v20
    v_lshl_add_u32 v20, v127, 3, v20
    v_lshl_add_u32 v21, v128, 2, v126
    v_mul_u32_u24 v21, 80, v21
    v_lshl_add_u32 v21, v127, 3, v21
    s_and_b32 s60, s16, 1
    s_lshl_b32 s60, s60, 5
    v_add_u32 v22, s60, v20
    v_add_u32 v23, s60, v21
    s_lshl_b32 s60, s16, 10
    s_add_u32 s60, s60, 73728
    v_add_u32 v24, s60, v224
    v_add_u32 v25, 36864, v24
    s_waitcnt lgkmcnt(0)
    s_barrier
    ds_read_b64_tr_b16 v[186:187], v20 offset:0
    ds_read_b64_tr_b16 v[188:189], v20 offset:320
    ds_read_b64_tr_b16 v[230:231], v20 offset:32
    ds_read_b64_tr_b16 v[232:233], v20 offset:352
    ds_read_b64_tr_b16 v[190:191], v20 offset:2560
    ds_read_b64_tr_b16 v[192:193], v20 offset:2880
    ds_read_b64_tr_b16 v[234:235], v20 offset:2592
    ds_read_b64_tr_b16 v[236:237], v20 offset:2912
    ds_read_b64_tr_b16 v[194:195], v20 offset:5120
    ds_read_b64_tr_b16 v[196:197], v20 offset:5440
    ds_read_b64_tr_b16 v[238:239], v20 offset:5152
    ds_read_b64_tr_b16 v[240:241], v20 offset:5472
    ds_read_b64_tr_b16 v[198:199], v20 offset:7680
    ds_read_b64_tr_b16 v[200:201], v20 offset:8000
    ds_read_b64_tr_b16 v[242:243], v20 offset:7712
    ds_read_b64_tr_b16 v[244:245], v20 offset:8032
    ds_read_b64_tr_b16 v[202:203], v21 offset:10240
    ds_read_b64_tr_b16 v[246:247], v21 offset:10272
    s_waitcnt lgkmcnt(14)
    s_waitcnt lgkmcnt(14)
    v_mfma_f32_16x16x32_bf16 v[0:3], a[134:137], v[186:189], v[0:3]
    v_mfma_f32_16x16x32_bf16 v[4:7], a[134:137], v[230:233], v[4:7]
    v_mfma_f32_16x16x32_bf16 v[8:11], a[196:199], v[186:189], v[8:11]
    v_mfma_f32_16x16x32_bf16 v[12:15], a[196:199], v[230:233], v[12:15]
    s_waitcnt lgkmcnt(10)
    v_mfma_f32_16x16x32_bf16 v[0:3], a[138:141], v[190:193], v[0:3]
    ds_read_b128 v[48:51], v24 offset:0
    v_mfma_f32_16x16x32_bf16 v[4:7], a[138:141], v[234:237], v[4:7]
    ds_read_b128 v[52:55], v24 offset:18432
    v_mfma_f32_16x16x32_bf16 v[8:11], a[200:203], v[190:193], v[8:11]
    ds_read_b128 v[56:59], v25 offset:0
    v_mfma_f32_16x16x32_bf16 v[12:15], a[200:203], v[234:237], v[12:15]
    ds_read_b128 v[60:63], v25 offset:18432
    s_waitcnt lgkmcnt(10)
    v_mfma_f32_16x16x32_bf16 v[0:3], a[142:145], v[194:197], v[0:3]
    ds_read_b128 v[64:67], v24 offset:4096
    v_mfma_f32_16x16x32_bf16 v[4:7], a[142:145], v[238:241], v[4:7]
    ds_read_b128 v[68:71], v24 offset:22528
    v_mfma_f32_16x16x32_bf16 v[8:11], a[204:207], v[194:197], v[8:11]
    ds_read_b128 v[72:75], v25 offset:4096
    v_mfma_f32_16x16x32_bf16 v[12:15], a[204:207], v[238:241], v[12:15]
    ds_read_b128 v[76:79], v25 offset:22528
    s_waitcnt lgkmcnt(10)
    v_mfma_f32_16x16x32_bf16 v[0:3], a[146:149], v[198:201], v[0:3]
    ds_read_b128 v[80:83], v24 offset:8192
    v_mfma_f32_16x16x32_bf16 v[4:7], a[146:149], v[242:245], v[4:7]
    ds_read_b128 v[84:87], v24 offset:26624
    v_mfma_f32_16x16x32_bf16 v[8:11], a[208:211], v[198:201], v[8:11]
    ds_read_b128 v[88:91], v25 offset:8192
    v_mfma_f32_16x16x32_bf16 v[12:15], a[208:211], v[242:245], v[12:15]
    ds_read_b128 v[92:95], v25 offset:26624
    s_waitcnt lgkmcnt(12)
    v_mfma_f32_16x16x16_bf16 v[0:3], a[150:151], v[202:203], v[0:3]
    v_mfma_f32_16x16x16_bf16 v[4:7], a[150:151], v[246:247], v[4:7]
    v_mfma_f32_16x16x16_bf16 v[8:11], a[212:213], v[202:203], v[8:11]
    s_nop 0
    v_mfma_f32_16x16x16_bf16 v[12:15], a[212:213], v[246:247], v[12:15]
    ds_read_b128 v[96:99], v24 offset:12288
    ds_read_b128 v[100:103], v24 offset:30720
    ds_read_b128 v[104:107], v25 offset:12288
    ds_read_b128 v[108:111], v25 offset:30720
    ds_read_b128 v[112:115], v24 offset:16384
    ds_read_b128 v[116:119], v24 offset:34816
    ds_read_b128 v[120:123], v25 offset:16384
    ds_read_b128 v[124:127], v25 offset:34816
    s_cmp_ge_u32 s16, 2
    s_cbranch_scc1 Lt_ynou4
    ds_read_b64_tr_b16 v[154:155], v22 offset:0
    ds_read_b64_tr_b16 v[156:157], v22 offset:320
    ds_read_b64_tr_b16 v[158:159], v22 offset:2560
    ds_read_b64_tr_b16 v[160:161], v22 offset:2880
    ds_read_b64_tr_b16 v[162:163], v22 offset:5120
    ds_read_b64_tr_b16 v[164:165], v22 offset:5440
    ds_read_b64_tr_b16 v[166:167], v22 offset:7680
    ds_read_b64_tr_b16 v[168:169], v22 offset:8000
    ds_read_b64_tr_b16 v[170:171], v23 offset:10240
    s_waitcnt lgkmcnt(0)
    v_mfma_f32_16x16x32_bf16 v[16:19], a[214:217], v[154:157], v[16:19]
    v_mfma_f32_16x16x32_bf16 v[16:19], a[218:221], v[158:161], v[16:19]
    v_mfma_f32_16x16x32_bf16 v[16:19], a[222:225], v[162:165], v[16:19]
    v_mfma_f32_16x16x32_bf16 v[16:19], a[226:229], v[166:169], v[16:19]
    s_nop 5
    v_mfma_f32_16x16x16_bf16 v[16:19], a[230:231], v[170:171], v[16:19]
Lt_ynou4:
    s_waitcnt lgkmcnt(0)
    v_pk_add_f32 v[48:49], v[48:49], v[52:53]
    v_pk_add_f32 v[56:57], v[56:57], v[60:61]
    v_pk_add_f32 v[50:51], v[50:51], v[54:55]
    v_pk_add_f32 v[58:59], v[58:59], v[62:63]
    v_pk_add_f32 v[48:49], v[48:49], v[56:57]
    v_pk_add_f32 v[50:51], v[50:51], v[58:59]
    v_pk_add_f32 v[64:65], v[64:65], v[68:69]
    v_pk_add_f32 v[72:73], v[72:73], v[76:77]
    v_pk_add_f32 v[66:67], v[66:67], v[70:71]
    v_pk_add_f32 v[74:75], v[74:75], v[78:79]
    v_pk_add_f32 v[64:65], v[64:65], v[72:73]
    v_pk_add_f32 v[66:67], v[66:67], v[74:75]
    v_pk_add_f32 v[80:81], v[80:81], v[84:85]
    v_pk_add_f32 v[88:89], v[88:89], v[92:93]
    v_pk_add_f32 v[82:83], v[82:83], v[86:87]
    v_pk_add_f32 v[90:91], v[90:91], v[94:95]
    v_pk_add_f32 v[80:81], v[80:81], v[88:89]
    v_pk_add_f32 v[82:83], v[82:83], v[90:91]
    v_pk_add_f32 v[96:97], v[96:97], v[100:101]
    v_pk_add_f32 v[104:105], v[104:105], v[108:109]
    v_pk_add_f32 v[98:99], v[98:99], v[102:103]
    v_pk_add_f32 v[106:107], v[106:107], v[110:111]
    v_pk_add_f32 v[96:97], v[96:97], v[104:105]
    v_pk_add_f32 v[98:99], v[98:99], v[106:107]
    v_pk_add_f32 v[112:113], v[112:113], v[116:117]
    v_pk_add_f32 v[120:121], v[120:121], v[124:125]
    v_pk_add_f32 v[114:115], v[114:115], v[118:119]
    v_pk_add_f32 v[122:123], v[122:123], v[126:127]
    v_pk_add_f32 v[112:113], v[112:113], v[120:121]
    v_pk_add_f32 v[114:115], v[114:115], v[122:123]
    s_mov_b32 s68, 0
    s_waitcnt vmcnt(0)
    s_cmp_eq_u32 s59, 0
    s_cbranch_scc1 Lt_rchk
    v_mov_b32 v32, 0
    v_mov_b32 v33, 0
    v_mov_b32 v34, 0
    v_mov_b32 v35, 0
    v_mov_b32 v36, 0
    v_mov_b32 v37, 0
    v_mov_b32 v38, 0
    v_mov_b32 v39, 0
    v_mov_b32 v40, 0
    v_mov_b32 v41, 0
    v_mov_b32 v42, 0
    v_mov_b32 v43, 0
    v_mov_b32 v44, 0
    v_mov_b32 v45, 0
    v_mov_b32 v46, 0
    v_mov_b32 v47, 0
    s_branch Lt_add
Lt_recv:
    buffer_load_dwordx4 v[32:35], v224, s[4:7], s69 offen offset:0 sc1
    buffer_load_dwordx4 v[36:39], v224, s[4:7], s69 offen offset:1024 sc1
    buffer_load_dwordx4 v[40:43], v224, s[4:7], s69 offen offset:2048 sc1
    buffer_load_dwordx4 v[44:47], v224, s[4:7], s69 offen offset:3072 sc1
    s_waitcnt vmcnt(0)
Lt_rchk:
    v_cmp_eq_u32 vcc, s20, v35
    v_cmp_eq_u32 s[62:63], s20, v39
    s_nop 0
    s_and_b64 vcc, vcc, s[62:63]
    v_cmp_eq_u32 s[62:63], s20, v43
    s_nop 0
    s_and_b64 vcc, vcc, s[62:63]
    v_cmp_eq_u32 s[62:63], s20, v47
    s_nop 0
    s_and_b64 vcc, vcc, s[62:63]
    s_cmp_eq_u64 vcc, -1
    s_cbranch_scc1 Lt_got
    s_add_u32 s68, s68, 1
    s_cmp_lt_u32 s68, 200000
    s_cbranch_scc1 Lt_recv
Lt_got:
    v_add_f32 v140, v140, v45
    v_add_f32 v141, v141, v46
    v_mov_b32 v35, v38
    v_mov_b32 v47, 0x71800000
    v_cmp_gt_f32 vcc, v47, v140
    v_cmp_gt_f32 s[62:63], v47, v141
    v_mov_b32 v43, v44
    s_nop 0
    s_and_b64 vcc, vcc, s[62:63]
    s_cmp_eq_u64 vcc, -1
    s_cbranch_scc0 Lf_start
Lt_add:
    v_mfma_f32_16x16x16_bf16 v[48:51], v[182:183], v[32:33], v[48:51]
    v_mfma_f32_16x16x16_bf16 v[64:67], v[182:183], v[34:35], v[64:67]
    v_mfma_f32_16x16x16_bf16 v[80:83], v[182:183], v[36:37], v[80:83]
    v_mfma_f32_16x16x16_bf16 v[96:99], v[182:183], v[40:41], v[96:99]
    v_mfma_f32_16x16x16_bf16 v[112:115], v[182:183], v[42:43], v[112:115]
    v_rcp_f32 v140, v140
    v_and_b32 v26, 15, v220
    v_mul_u32_u24 v26, 288, v26
    v_lshl_add_u32 v26, v128, 3, v26
    s_and_b32 s62, s16, 1
    s_mul_i32 s62, s62, 4608
    s_lshr_b32 s63, s16, 1
    s_lshl_b32 s63, s63, 5
    s_add_u32 s62, s62, s63
    s_add_u32 s62, s62, 36864
    v_add_u32 v26, s62, v26
    v_and_b32 v27, 15, v220
    v_mul_u32_u24 v27, 288, v27
    v_lshl_add_u32 v28, v128, 3, v27
    v_lshl_add_u32 v27, v128, 4, v27
    s_and_b32 s60, s16, 1
    s_mul_i32 s60, s60, 4608
    v_add_u32 v29, s60, v27
    v_add_u32 v30, s60, v28
    v_mul_f32 v48, v48, v140
    v_mul_f32 v49, v49, v140
    v_mul_f32 v50, v50, v140
    v_mul_f32 v51, v51, v140
    v_cvt_pk_bf16_f32 v48, v48, v49
    v_cvt_pk_bf16_f32 v49, v50, v51
    ds_write_b64 v26, v[48:49] offset:0
    v_mul_f32 v64, v64, v140
    v_mul_f32 v65, v65, v140
    v_mul_f32 v66, v66, v140
    v_mul_f32 v67, v67, v140
    v_cvt_pk_bf16_f32 v64, v64, v65
    v_cvt_pk_bf16_f32 v65, v66, v67
    ds_write_b64 v26, v[64:65] offset:64
    v_mul_f32 v80, v80, v140
    v_mul_f32 v81, v81, v140
    v_mul_f32 v82, v82, v140
    v_mul_f32 v83, v83, v140
    v_cvt_pk_bf16_f32 v80, v80, v81
    v_cvt_pk_bf16_f32 v81, v82, v83
    ds_write_b64 v26, v[80:81] offset:128
    v_mul_f32 v96, v96, v140
    v_mul_f32 v97, v97, v140
    v_mul_f32 v98, v98, v140
    v_mul_f32 v99, v99, v140
    v_cvt_pk_bf16_f32 v96, v96, v97
    v_cvt_pk_bf16_f32 v97, v98, v99
    ds_write_b64 v26, v[96:97] offset:192
    v_mul_f32 v112, v112, v140
    v_mul_f32 v113, v113, v140
    v_mul_f32 v114, v114, v140
    v_mul_f32 v115, v115, v140
    v_cvt_pk_bf16_f32 v112, v112, v113
    v_cvt_pk_bf16_f32 v113, v114, v115
    s_cmp_ge_u32 s16, 2
    s_cbranch_scc1 Lt_noq4
    ds_write_b64 v26, v[112:113] offset:256
Lt_noq4:
    s_waitcnt lgkmcnt(0)
    s_barrier
    ds_read_b128 v[186:189], v27 offset:36864
    ds_read_b128 v[230:233], v27 offset:41472
    ds_read_b128 v[190:193], v27 offset:36928
    ds_read_b128 v[234:237], v27 offset:41536
    ds_read_b128 v[194:197], v27 offset:36992
    ds_read_b128 v[238:241], v27 offset:41600
    ds_read_b128 v[198:201], v27 offset:37056
    ds_read_b128 v[242:245], v27 offset:41664
    ds_read_b64 v[202:203], v28 offset:37120
    ds_read_b64 v[246:247], v28 offset:41728
    s_mov_b32 s28, s54
    s_mov_b32 s29, s55
    s_mov_b32 s30, 2304000
    s_mov_b32 s31, 0x00020000
    s_cmp_ge_u32 s16, 2
    s_cbranch_scc1 Lt_onou4
    ds_read_b128 v[154:157], v29 offset:36864
    ds_read_b128 v[158:161], v29 offset:36928
    ds_read_b128 v[162:165], v29 offset:36992
    ds_read_b128 v[166:169], v29 offset:37056
    ds_read_b64 v[170:171], v30 offset:37120
    s_waitcnt lgkmcnt(0)
    v_mfma_f32_16x16x32_bf16 v[16:19], a[116:119], v[154:157], v[16:19]
    v_mfma_f32_16x16x32_bf16 v[16:19], a[120:123], v[158:161], v[16:19]
    v_mfma_f32_16x16x32_bf16 v[16:19], a[124:127], v[162:165], v[16:19]
    v_mfma_f32_16x16x32_bf16 v[16:19], a[128:131], v[166:169], v[16:19]
    s_nop 5
    v_mfma_f32_16x16x16_bf16 v[16:19], a[132:133], v[170:171], v[16:19]
Lt_onou4:
    s_waitcnt lgkmcnt(8)
    v_mfma_f32_16x16x32_bf16 v[0:3], a[80:83], v[186:189], v[0:3]
    v_mfma_f32_16x16x32_bf16 v[4:7], a[80:83], v[230:233], v[4:7]
    v_mfma_f32_16x16x32_bf16 v[8:11], a[98:101], v[186:189], v[8:11]
    v_mfma_f32_16x16x32_bf16 v[12:15], a[98:101], v[230:233], v[12:15]
    s_waitcnt lgkmcnt(6)
    v_mfma_f32_16x16x32_bf16 v[0:3], a[84:87], v[190:193], v[0:3]
    v_mfma_f32_16x16x32_bf16 v[4:7], a[84:87], v[234:237], v[4:7]
    v_mfma_f32_16x16x32_bf16 v[8:11], a[102:105], v[190:193], v[8:11]
    v_mfma_f32_16x16x32_bf16 v[12:15], a[102:105], v[234:237], v[12:15]
    s_waitcnt lgkmcnt(4)
    v_mfma_f32_16x16x32_bf16 v[0:3], a[88:91], v[194:197], v[0:3]
    v_mfma_f32_16x16x32_bf16 v[4:7], a[88:91], v[238:241], v[4:7]
    v_mfma_f32_16x16x32_bf16 v[8:11], a[106:109], v[194:197], v[8:11]
    v_mfma_f32_16x16x32_bf16 v[12:15], a[106:109], v[238:241], v[12:15]
    s_waitcnt lgkmcnt(2)
    v_mfma_f32_16x16x32_bf16 v[0:3], a[92:95], v[198:201], v[0:3]
    v_mfma_f32_16x16x32_bf16 v[4:7], a[92:95], v[242:245], v[4:7]
    v_mfma_f32_16x16x32_bf16 v[8:11], a[110:113], v[198:201], v[8:11]
    v_mfma_f32_16x16x32_bf16 v[12:15], a[110:113], v[242:245], v[12:15]
    s_waitcnt lgkmcnt(0)
    s_nop 1
    v_mfma_f32_16x16x16_bf16 v[0:3], a[96:97], v[202:203], v[0:3]
    v_mfma_f32_16x16x16_bf16 v[4:7], a[96:97], v[246:247], v[4:7]
    v_mfma_f32_16x16x16_bf16 v[8:11], a[114:115], v[202:203], v[8:11]
    v_mfma_f32_16x16x16_bf16 v[12:15], a[114:115], v[246:247], v[12:15]
    s_nop 4
    v_cvt_pk_bf16_f32 v0, v0, v1
    v_cvt_pk_bf16_f32 v1, v2, v3
    buffer_store_dwordx2 v[0:1], v227, s[28:31], s71 offen offset:0
    v_cvt_pk_bf16_f32 v4, v4, v5
    v_cvt_pk_bf16_f32 v5, v6, v7
    buffer_store_dwordx2 v[4:5], v228, s[28:31], s71 offen offset:0
    v_cvt_pk_bf16_f32 v8, v8, v9
    v_cvt_pk_bf16_f32 v9, v10, v11
    buffer_store_dwordx2 v[8:9], v227, s[28:31], s71 offen offset:128
    v_cvt_pk_bf16_f32 v12, v12, v13
    v_cvt_pk_bf16_f32 v13, v14, v15
    buffer_store_dwordx2 v[12:13], v228, s[28:31], s71 offen offset:128
    s_cmp_ge_u32 s16, 2
    s_cbranch_scc1 Lt_exit
    v_cvt_pk_bf16_f32 v16, v16, v17
    v_cvt_pk_bf16_f32 v17, v18, v19
    buffer_store_dwordx2 v[16:17], v227, s[28:31], s70 offen
Lt_exit:
    s_branch Lk_done
Lw_start:
    s_and_b32 s70, s2, 1
    s_cmp_ge_u32 s2, 254
    s_cbranch_scc1 Lw_d
    s_mov_b32 s24, s42
    s_mov_b32 s25, s43
    s_mov_b32 s26, 41472
    s_mov_b32 s27, 0x00020000
    s_mov_b32 s28, s44
    s_mov_b32 s29, s45
    s_mov_b32 s30, 41472
    s_mov_b32 s31, 0x00020000
    s_mov_b32 s32, s52
    s_mov_b32 s33, s53
    s_mov_b32 s34, 41472
    s_mov_b32 s35, 0x00020000
    s_mov_b32 s71, 0
    s_mov_b32 s72, 1
    s_branch Lw_c
Lw_d:
    s_mov_b32 s24, s50
    s_mov_b32 s25, s51
    s_mov_b32 s26, 41472
    s_mov_b32 s27, 0x00020000
    s_mov_b32 s28, s52
    s_mov_b32 s29, s53
    s_mov_b32 s30, 41472
    s_mov_b32 s31, 0x00020000
    s_add_u32 s32, s52, 41472
    s_addc_u32 s33, s53, 0
    s_mov_b32 s34, 41472
    s_mov_b32 s35, 0x00020000
    s_mov_b32 s71, 1
    s_mov_b32 s72, 0
Lw_c:
    s_mul_i32 s60, s16, 10240
    s_add_u32 s61, s60, 0
    s_add_u32 m0, s61, 0
    s_nop 0
    buffer_load_dwordx4 v7, s[28:31], s61 offen offset:0 lds
    buffer_load_dwordx4 v7, s[28:31], s61 offen offset:1024 lds
    buffer_load_dwordx4 v7, s[28:31], s61 offen offset:2048 lds
    buffer_load_dwordx4 v7, s[28:31], s61 offen offset:3072 lds
    s_add_u32 s61, s60, 4096
    s_add_u32 m0, s61, 0
    s_nop 0
    buffer_load_dwordx4 v7, s[28:31], s61 offen offset:0 lds
    buffer_load_dwordx4 v7, s[28:31], s61 offen offset:1024 lds
    buffer_load_dwordx4 v7, s[28:31], s61 offen offset:2048 lds
    buffer_load_dwordx4 v7, s[28:31], s61 offen offset:3072 lds
    s_add_u32 s61, s60, 8192
    s_add_u32 m0, s61, 0
    s_nop 0
    buffer_load_dwordx4 v7, s[28:31], s61 offen offset:0 lds
    buffer_load_dwordx4 v7, s[28:31], s61 offen offset:1024 lds
    buffer_load_dwordx4 v7, s[28:31], s61 offen offset:2048 lds
    s_mul_i32 s60, s16, 10240
    s_add_u32 s61, s60, 0
    s_add_u32 m0, s61, 41984
    s_nop 0
    buffer_load_dwordx4 v7, s[32:35], s61 offen offset:0 lds
    buffer_load_dwordx4 v7, s[32:35], s61 offen offset:1024 lds
    buffer_load_dwordx4 v7, s[32:35], s61 offen offset:2048 lds
    buffer_load_dwordx4 v7, s[32:35], s61 offen offset:3072 lds
    s_add_u32 s61, s60, 4096
    s_add_u32 m0, s61, 41984
    s_nop 0
    buffer_load_dwordx4 v7, s[32:35], s61 offen offset:0 lds
    buffer_load_dwordx4 v7, s[32:35], s61 offen offset:1024 lds
    buffer_load_dwordx4 v7, s[32:35], s61 offen offset:2048 lds
    buffer_load_dwordx4 v7, s[32:35], s61 offen offset:3072 lds
    s_add_u32 s61, s60, 8192
    s_add_u32 m0, s61, 41984
    s_nop 0
    buffer_load_dwordx4 v7, s[32:35], s61 offen offset:0 lds
    buffer_load_dwordx4 v7, s[32:35], s61 offen offset:1024 lds
    buffer_load_dwordx4 v7, s[32:35], s61 offen offset:2048 lds
    v_add_u32 v22, 41984, v4
    s_lshl_b32 s73, s70, 2
    s_add_u32 s73, s73, s16
    s_waitcnt vmcnt(0) lgkmcnt(0)
    s_barrier
Lw_round:
    s_lshl_b32 s60, s73, 4
    v_add_u32 v8, s60, v1
    v_mul_u32_u24 v3, 288, v8
    v_lshl_add_u32 v3, v2, 3, v3
    buffer_load_dwordx2 v[140:141], v3, s[24:27], 0 offen offset:0
    buffer_load_dwordx2 v[142:143], v3, s[24:27], 0 offen offset:32
    buffer_load_dwordx2 v[144:145], v3, s[24:27], 0 offen offset:64
    buffer_load_dwordx2 v[146:147], v3, s[24:27], 0 offen offset:96
    buffer_load_dwordx2 v[148:149], v3, s[24:27], 0 offen offset:128
    buffer_load_dwordx2 v[150:151], v3, s[24:27], 0 offen offset:160
    buffer_load_dwordx2 v[152:153], v3, s[24:27], 0 offen offset:192
    buffer_load_dwordx2 v[154:155], v3, s[24:27], 0 offen offset:224
    buffer_load_dwordx2 v[156:157], v3, s[24:27], 0 offen offset:256
    s_waitcnt vmcnt(0)
    s_cmp_eq_u32 s72, 0
    s_cbranch_scc1 Lw_b
    ds_read_b64_tr_b16 v[24:25], v4 offset:0
    ds_read_b64_tr_b16 v[26:27], v4 offset:4608
    ds_read_b64_tr_b16 v[28:29], v4 offset:9216
    ds_read_b64_tr_b16 v[30:31], v4 offset:13824
    ds_read_b64_tr_b16 v[32:33], v4 offset:18432
    ds_read_b64_tr_b16 v[34:35], v4 offset:23040
    ds_read_b64_tr_b16 v[36:37], v4 offset:27648
    ds_read_b64_tr_b16 v[38:39], v4 offset:32256
    ds_read_b64_tr_b16 v[72:73], v4 offset:36864
    ds_read_b64_tr_b16 v[40:41], v4 offset:32
    ds_read_b64_tr_b16 v[42:43], v4 offset:4640
    ds_read_b64_tr_b16 v[44:45], v4 offset:9248
    ds_read_b64_tr_b16 v[46:47], v4 offset:13856
    ds_read_b64_tr_b16 v[48:49], v4 offset:18464
    ds_read_b64_tr_b16 v[50:51], v4 offset:23072
    ds_read_b64_tr_b16 v[52:53], v4 offset:27680
    ds_read_b64_tr_b16 v[54:55], v4 offset:32288
    ds_read_b64_tr_b16 v[74:75], v4 offset:36896
    s_waitcnt lgkmcnt(9)
    v_mfma_f32_16x16x32_bf16 v[84:87], v[24:27], v[140:143], 0
    ds_read_b64_tr_b16 v[56:57], v4 offset:64
    ds_read_b64_tr_b16 v[58:59], v4 offset:4672
    ds_read_b64_tr_b16 v[60:61], v4 offset:9280
    v_mfma_f32_16x16x32_bf16 v[84:87], v[28:31], v[144:147], v[84:87]
    ds_read_b64_tr_b16 v[62:63], v4 offset:13888
    ds_read_b64_tr_b16 v[64:65], v4 offset:18496
    v_mfma_f32_16x16x32_bf16 v[84:87], v[32:35], v[148:151], v[84:87]
    ds_read_b64_tr_b16 v[66:67], v4 offset:23104
    ds_read_b64_tr_b16 v[68:69], v4 offset:27712
    v_mfma_f32_16x16x32_bf16 v[84:87], v[36:39], v[152:155], v[84:87]
    ds_read_b64_tr_b16 v[70:71], v4 offset:32320
    ds_read_b64_tr_b16 v[76:77], v4 offset:36928
    s_waitcnt lgkmcnt(9)
    v_mfma_f32_16x16x32_bf16 v[88:91], v[40:43], v[140:143], 0
    ds_read_b64_tr_b16 v[24:25], v4 offset:96
    ds_read_b64_tr_b16 v[26:27], v4 offset:4704
    v_mfma_f32_16x16x32_bf16 v[88:91], v[44:47], v[144:147], v[88:91]
    ds_read_b64_tr_b16 v[28:29], v4 offset:9312
    ds_read_b64_tr_b16 v[30:31], v4 offset:13920
    v_mfma_f32_16x16x16_bf16 v[84:87], v[72:73], v[156:157], v[84:87]
    ds_read_b64_tr_b16 v[32:33], v4 offset:18528
    ds_read_b64_tr_b16 v[34:35], v4 offset:23136
    v_mfma_f32_16x16x32_bf16 v[88:91], v[48:51], v[148:151], v[88:91]
    ds_read_b64_tr_b16 v[36:37], v4 offset:27744
    ds_read_b64_tr_b16 v[38:39], v4 offset:32352
    v_mfma_f32_16x16x32_bf16 v[88:91], v[52:55], v[152:155], v[88:91]
    ds_read_b64_tr_b16 v[78:79], v4 offset:36960
    s_waitcnt lgkmcnt(9)
    v_mfma_f32_16x16x32_bf16 v[92:95], v[56:59], v[140:143], 0
    ds_read_b64_tr_b16 v[40:41], v4 offset:128
    ds_read_b64_tr_b16 v[42:43], v4 offset:4736
    v_mfma_f32_16x16x32_bf16 v[92:95], v[60:63], v[144:147], v[92:95]
    ds_read_b64_tr_b16 v[44:45], v4 offset:9344
    ds_read_b64_tr_b16 v[46:47], v4 offset:13952
    v_mfma_f32_16x16x16_bf16 v[88:91], v[74:75], v[156:157], v[88:91]
    ds_read_b64_tr_b16 v[48:49], v4 offset:18560
    ds_read_b64_tr_b16 v[50:51], v4 offset:23168
    v_mfma_f32_16x16x32_bf16 v[92:95], v[64:67], v[148:151], v[92:95]
    ds_read_b64_tr_b16 v[52:53], v4 offset:27776
    ds_read_b64_tr_b16 v[54:55], v4 offset:32384
    v_mfma_f32_16x16x32_bf16 v[92:95], v[68:71], v[152:155], v[92:95]
    ds_read_b64_tr_b16 v[72:73], v4 offset:36992
    s_waitcnt lgkmcnt(9)
    v_mfma_f32_16x16x32_bf16 v[96:99], v[24:27], v[140:143], 0
    ds_read_b64_tr_b16 v[56:57], v4 offset:160
    ds_read_b64_tr_b16 v[58:59], v4 offset:4768
    v_mfma_f32_16x16x32_bf16 v[96:99], v[28:31], v[144:147], v[96:99]
    ds_read_b64_tr_b16 v[60:61], v4 offset:9376
    ds_read_b64_tr_b16 v[62:63], v4 offset:13984
    v_mfma_f32_16x16x16_bf16 v[92:95], v[76:77], v[156:157], v[92:95]
    ds_read_b64_tr_b16 v[64:65], v4 offset:18592
    ds_read_b64_tr_b16 v[66:67], v4 offset:23200
    v_mfma_f32_16x16x32_bf16 v[96:99], v[32:35], v[148:151], v[96:99]
    ds_read_b64_tr_b16 v[68:69], v4 offset:27808
    ds_read_b64_tr_b16 v[70:71], v4 offset:32416
    v_mfma_f32_16x16x32_bf16 v[96:99], v[36:39], v[152:155], v[96:99]
    ds_read_b64_tr_b16 v[74:75], v4 offset:37024
    s_waitcnt lgkmcnt(9)
    v_mfma_f32_16x16x32_bf16 v[100:103], v[40:43], v[140:143], 0
    ds_read_b64_tr_b16 v[24:25], v4 offset:192
    ds_read_b64_tr_b16 v[26:27], v4 offset:4800
    v_mfma_f32_16x16x32_bf16 v[100:103], v[44:47], v[144:147], v[100:103]
    ds_read_b64_tr_b16 v[28:29], v4 offset:9408
    ds_read_b64_tr_b16 v[30:31], v4 offset:14016
    v_mfma_f32_16x16x16_bf16 v[96:99], v[78:79], v[156:157], v[96:99]
    ds_read_b64_tr_b16 v[32:33], v4 offset:18624
    ds_read_b64_tr_b16 v[34:35], v4 offset:23232
    v_mfma_f32_16x16x32_bf16 v[100:103], v[48:51], v[148:151], v[100:103]
    ds_read_b64_tr_b16 v[36:37], v4 offset:27840
    ds_read_b64_tr_b16 v[38:39], v4 offset:32448
    v_mfma_f32_16x16x32_bf16 v[100:103], v[52:55], v[152:155], v[100:103]
    ds_read_b64_tr_b16 v[76:77], v4 offset:37056
    s_waitcnt lgkmcnt(9)
    v_mfma_f32_16x16x32_bf16 v[104:107], v[56:59], v[140:143], 0
    ds_read_b64_tr_b16 v[40:41], v4 offset:224
    ds_read_b64_tr_b16 v[42:43], v4 offset:4832
    v_mfma_f32_16x16x32_bf16 v[104:107], v[60:63], v[144:147], v[104:107]
    ds_read_b64_tr_b16 v[44:45], v4 offset:9440
    ds_read_b64_tr_b16 v[46:47], v4 offset:14048
    v_mfma_f32_16x16x16_bf16 v[100:103], v[72:73], v[156:157], v[100:103]
    ds_read_b64_tr_b16 v[48:49], v4 offset:18656
    ds_read_b64_tr_b16 v[50:51], v4 offset:23264
    v_mfma_f32_16x16x32_bf16 v[104:107], v[64:67], v[148:151], v[104:107]
    ds_read_b64_tr_b16 v[52:53], v4 offset:27872
    ds_read_b64_tr_b16 v[54:55], v4 offset:32480
    v_mfma_f32_16x16x32_bf16 v[104:107], v[68:71], v[152:155], v[104:107]
    ds_read_b64_tr_b16 v[78:79], v4 offset:37088
    s_waitcnt lgkmcnt(9)
    v_mfma_f32_16x16x32_bf16 v[108:111], v[24:27], v[140:143], 0
    ds_read_b64_tr_b16 v[56:57], v4 offset:256
    ds_read_b64_tr_b16 v[58:59], v4 offset:4864
    v_mfma_f32_16x16x32_bf16 v[108:111], v[28:31], v[144:147], v[108:111]
    ds_read_b64_tr_b16 v[60:61], v4 offset:9472
    ds_read_b64_tr_b16 v[62:63], v4 offset:14080
    v_mfma_f32_16x16x16_bf16 v[104:107], v[74:75], v[156:157], v[104:107]
    ds_read_b64_tr_b16 v[64:65], v4 offset:18688
    ds_read_b64_tr_b16 v[66:67], v4 offset:23296
    v_mfma_f32_16x16x32_bf16 v[108:111], v[32:35], v[148:151], v[108:111]
    ds_read_b64_tr_b16 v[68:69], v4 offset:27904
    ds_read_b64_tr_b16 v[70:71], v4 offset:32512
    v_mfma_f32_16x16x32_bf16 v[108:111], v[36:39], v[152:155], v[108:111]
    ds_read_b64_tr_b16 v[72:73], v4 offset:37120
    s_waitcnt lgkmcnt(9)
    v_mfma_f32_16x16x32_bf16 v[112:115], v[40:43], v[140:143], 0
    v_mfma_f32_16x16x32_bf16 v[112:115], v[44:47], v[144:147], v[112:115]
    s_nop 1
    v_mfma_f32_16x16x16_bf16 v[108:111], v[76:77], v[156:157], v[108:111]
    v_mfma_f32_16x16x32_bf16 v[112:115], v[48:51], v[148:151], v[112:115]
    v_mfma_f32_16x16x32_bf16 v[112:115], v[52:55], v[152:155], v[112:115]
    s_waitcnt lgkmcnt(0)
    v_mfma_f32_16x16x32_bf16 v[116:119], v[56:59], v[140:143], 0
    v_mfma_f32_16x16x32_bf16 v[116:119], v[60:63], v[144:147], v[116:119]
    s_nop 2
    v_mfma_f32_16x16x16_bf16 v[112:115], v[78:79], v[156:157], v[112:115]
    v_mfma_f32_16x16x32_bf16 v[116:119], v[64:67], v[148:151], v[116:119]
    v_mfma_f32_16x16x32_bf16 v[116:119], v[68:71], v[152:155], v[116:119]
    s_nop 5
    v_mfma_f32_16x16x16_bf16 v[116:119], v[72:73], v[156:157], v[116:119]
    v_cvt_pk_bf16_f32 v140, v84, v85
    v_cvt_pk_bf16_f32 v141, v86, v87
    v_cvt_pk_bf16_f32 v142, v88, v89
    v_cvt_pk_bf16_f32 v143, v90, v91
    v_cvt_pk_bf16_f32 v144, v92, v93
    v_cvt_pk_bf16_f32 v145, v94, v95
    v_cvt_pk_bf16_f32 v146, v96, v97
    v_cvt_pk_bf16_f32 v147, v98, v99
    v_cvt_pk_bf16_f32 v148, v100, v101
    v_cvt_pk_bf16_f32 v149, v102, v103
    v_cvt_pk_bf16_f32 v150, v104, v105
    v_cvt_pk_bf16_f32 v151, v106, v107
    v_cvt_pk_bf16_f32 v152, v108, v109
    v_cvt_pk_bf16_f32 v153, v110, v111
    v_cvt_pk_bf16_f32 v154, v112, v113
    v_cvt_pk_bf16_f32 v155, v114, v115
    v_cvt_pk_bf16_f32 v156, v116, v117
    v_cvt_pk_bf16_f32 v157, v118, v119
Lw_b:
    ds_read_b64_tr_b16 v[24:25], v22 offset:0
    ds_read_b64_tr_b16 v[26:27], v22 offset:4608
    ds_read_b64_tr_b16 v[28:29], v22 offset:9216
    ds_read_b64_tr_b16 v[30:31], v22 offset:13824
    ds_read_b64_tr_b16 v[32:33], v22 offset:18432
    ds_read_b64_tr_b16 v[34:35], v22 offset:23040
    ds_read_b64_tr_b16 v[36:37], v22 offset:27648
    ds_read_b64_tr_b16 v[38:39], v22 offset:32256
    ds_read_b64_tr_b16 v[72:73], v22 offset:36864
    ds_read_b64_tr_b16 v[40:41], v22 offset:32
    ds_read_b64_tr_b16 v[42:43], v22 offset:4640
    ds_read_b64_tr_b16 v[44:45], v22 offset:9248
    ds_read_b64_tr_b16 v[46:47], v22 offset:13856
    ds_read_b64_tr_b16 v[48:49], v22 offset:18464
    ds_read_b64_tr_b16 v[50:51], v22 offset:23072
    ds_read_b64_tr_b16 v[52:53], v22 offset:27680
    ds_read_b64_tr_b16 v[54:55], v22 offset:32288
    ds_read_b64_tr_b16 v[74:75], v22 offset:36896
    s_waitcnt lgkmcnt(9)
    v_mfma_f32_16x16x32_bf16 v[84:87], v[140:143], v[24:27], 0
    ds_read_b64_tr_b16 v[56:57], v22 offset:64
    ds_read_b64_tr_b16 v[58:59], v22 offset:4672
    ds_read_b64_tr_b16 v[60:61], v22 offset:9280
    v_mfma_f32_16x16x32_bf16 v[84:87], v[144:147], v[28:31], v[84:87]
    ds_read_b64_tr_b16 v[62:63], v22 offset:13888
    ds_read_b64_tr_b16 v[64:65], v22 offset:18496
    v_mfma_f32_16x16x32_bf16 v[84:87], v[148:151], v[32:35], v[84:87]
    ds_read_b64_tr_b16 v[66:67], v22 offset:23104
    ds_read_b64_tr_b16 v[68:69], v22 offset:27712
    v_mfma_f32_16x16x32_bf16 v[84:87], v[152:155], v[36:39], v[84:87]
    ds_read_b64_tr_b16 v[70:71], v22 offset:32320
    ds_read_b64_tr_b16 v[76:77], v22 offset:36928
    s_waitcnt lgkmcnt(9)
    v_mfma_f32_16x16x32_bf16 v[88:91], v[140:143], v[40:43], 0
    ds_read_b64_tr_b16 v[24:25], v22 offset:96
    ds_read_b64_tr_b16 v[26:27], v22 offset:4704
    v_mfma_f32_16x16x32_bf16 v[88:91], v[144:147], v[44:47], v[88:91]
    ds_read_b64_tr_b16 v[28:29], v22 offset:9312
    ds_read_b64_tr_b16 v[30:31], v22 offset:13920
    v_mfma_f32_16x16x16_bf16 v[84:87], v[156:157], v[72:73], v[84:87]
    ds_read_b64_tr_b16 v[32:33], v22 offset:18528
    ds_read_b64_tr_b16 v[34:35], v22 offset:23136
    v_mfma_f32_16x16x32_bf16 v[88:91], v[148:151], v[48:51], v[88:91]
    ds_read_b64_tr_b16 v[36:37], v22 offset:27744
    ds_read_b64_tr_b16 v[38:39], v22 offset:32352
    v_mfma_f32_16x16x32_bf16 v[88:91], v[152:155], v[52:55], v[88:91]
    ds_read_b64_tr_b16 v[78:79], v22 offset:36960
    s_waitcnt lgkmcnt(9)
    v_mfma_f32_16x16x32_bf16 v[92:95], v[140:143], v[56:59], 0
    ds_read_b64_tr_b16 v[40:41], v22 offset:128
    ds_read_b64_tr_b16 v[42:43], v22 offset:4736
    v_mfma_f32_16x16x32_bf16 v[92:95], v[144:147], v[60:63], v[92:95]
    ds_read_b64_tr_b16 v[44:45], v22 offset:9344
    ds_read_b64_tr_b16 v[46:47], v22 offset:13952
    v_mfma_f32_16x16x16_bf16 v[88:91], v[156:157], v[74:75], v[88:91]
    ds_read_b64_tr_b16 v[48:49], v22 offset:18560
    ds_read_b64_tr_b16 v[50:51], v22 offset:23168
    v_mfma_f32_16x16x32_bf16 v[92:95], v[148:151], v[64:67], v[92:95]
    ds_read_b64_tr_b16 v[52:53], v22 offset:27776
    ds_read_b64_tr_b16 v[54:55], v22 offset:32384
    v_mfma_f32_16x16x32_bf16 v[92:95], v[152:155], v[68:71], v[92:95]
    ds_read_b64_tr_b16 v[72:73], v22 offset:36992
    s_waitcnt lgkmcnt(9)
    v_mfma_f32_16x16x32_bf16 v[96:99], v[140:143], v[24:27], 0
    ds_read_b64_tr_b16 v[56:57], v22 offset:160
    ds_read_b64_tr_b16 v[58:59], v22 offset:4768
    v_mfma_f32_16x16x32_bf16 v[96:99], v[144:147], v[28:31], v[96:99]
    ds_read_b64_tr_b16 v[60:61], v22 offset:9376
    ds_read_b64_tr_b16 v[62:63], v22 offset:13984
    v_mfma_f32_16x16x16_bf16 v[92:95], v[156:157], v[76:77], v[92:95]
    ds_read_b64_tr_b16 v[64:65], v22 offset:18592
    ds_read_b64_tr_b16 v[66:67], v22 offset:23200
    v_mfma_f32_16x16x32_bf16 v[96:99], v[148:151], v[32:35], v[96:99]
    ds_read_b64_tr_b16 v[68:69], v22 offset:27808
    ds_read_b64_tr_b16 v[70:71], v22 offset:32416
    v_mfma_f32_16x16x32_bf16 v[96:99], v[152:155], v[36:39], v[96:99]
    ds_read_b64_tr_b16 v[74:75], v22 offset:37024
    s_waitcnt lgkmcnt(9)
    v_mfma_f32_16x16x32_bf16 v[100:103], v[140:143], v[40:43], 0
    ds_read_b64_tr_b16 v[24:25], v22 offset:192
    ds_read_b64_tr_b16 v[26:27], v22 offset:4800
    v_mfma_f32_16x16x32_bf16 v[100:103], v[144:147], v[44:47], v[100:103]
    ds_read_b64_tr_b16 v[28:29], v22 offset:9408
    ds_read_b64_tr_b16 v[30:31], v22 offset:14016
    v_mfma_f32_16x16x16_bf16 v[96:99], v[156:157], v[78:79], v[96:99]
    ds_read_b64_tr_b16 v[32:33], v22 offset:18624
    ds_read_b64_tr_b16 v[34:35], v22 offset:23232
    v_mfma_f32_16x16x32_bf16 v[100:103], v[148:151], v[48:51], v[100:103]
    ds_read_b64_tr_b16 v[36:37], v22 offset:27840
    ds_read_b64_tr_b16 v[38:39], v22 offset:32448
    v_mfma_f32_16x16x32_bf16 v[100:103], v[152:155], v[52:55], v[100:103]
    ds_read_b64_tr_b16 v[76:77], v22 offset:37056
    s_waitcnt lgkmcnt(9)
    v_mfma_f32_16x16x32_bf16 v[104:107], v[140:143], v[56:59], 0
    ds_read_b64_tr_b16 v[40:41], v22 offset:224
    ds_read_b64_tr_b16 v[42:43], v22 offset:4832
    v_mfma_f32_16x16x32_bf16 v[104:107], v[144:147], v[60:63], v[104:107]
    ds_read_b64_tr_b16 v[44:45], v22 offset:9440
    ds_read_b64_tr_b16 v[46:47], v22 offset:14048
    v_mfma_f32_16x16x16_bf16 v[100:103], v[156:157], v[72:73], v[100:103]
    ds_read_b64_tr_b16 v[48:49], v22 offset:18656
    ds_read_b64_tr_b16 v[50:51], v22 offset:23264
    v_mfma_f32_16x16x32_bf16 v[104:107], v[148:151], v[64:67], v[104:107]
    ds_read_b64_tr_b16 v[52:53], v22 offset:27872
    ds_read_b64_tr_b16 v[54:55], v22 offset:32480
    v_mfma_f32_16x16x32_bf16 v[104:107], v[152:155], v[68:71], v[104:107]
    ds_read_b64_tr_b16 v[78:79], v22 offset:37088
    s_waitcnt lgkmcnt(9)
    v_mfma_f32_16x16x32_bf16 v[108:111], v[140:143], v[24:27], 0
    ds_read_b64_tr_b16 v[56:57], v22 offset:256
    ds_read_b64_tr_b16 v[58:59], v22 offset:4864
    v_mfma_f32_16x16x32_bf16 v[108:111], v[144:147], v[28:31], v[108:111]
    ds_read_b64_tr_b16 v[60:61], v22 offset:9472
    ds_read_b64_tr_b16 v[62:63], v22 offset:14080
    v_mfma_f32_16x16x16_bf16 v[104:107], v[156:157], v[74:75], v[104:107]
    ds_read_b64_tr_b16 v[64:65], v22 offset:18688
    ds_read_b64_tr_b16 v[66:67], v22 offset:23296
    v_mfma_f32_16x16x32_bf16 v[108:111], v[148:151], v[32:35], v[108:111]
    ds_read_b64_tr_b16 v[68:69], v22 offset:27904
    ds_read_b64_tr_b16 v[70:71], v22 offset:32512
    v_mfma_f32_16x16x32_bf16 v[108:111], v[152:155], v[36:39], v[108:111]
    ds_read_b64_tr_b16 v[72:73], v22 offset:37120
    s_waitcnt lgkmcnt(9)
    v_mfma_f32_16x16x32_bf16 v[112:115], v[140:143], v[40:43], 0
    v_mfma_f32_16x16x32_bf16 v[112:115], v[144:147], v[44:47], v[112:115]
    s_nop 1
    v_mfma_f32_16x16x16_bf16 v[108:111], v[156:157], v[76:77], v[108:111]
    v_mfma_f32_16x16x32_bf16 v[112:115], v[148:151], v[48:51], v[112:115]
    v_mfma_f32_16x16x32_bf16 v[112:115], v[152:155], v[52:55], v[112:115]
    s_waitcnt lgkmcnt(0)
    v_mfma_f32_16x16x32_bf16 v[116:119], v[140:143], v[56:59], 0
    v_mfma_f32_16x16x32_bf16 v[116:119], v[144:147], v[60:63], v[116:119]
    s_nop 2
    v_mfma_f32_16x16x16_bf16 v[112:115], v[156:157], v[78:79], v[112:115]
    v_mfma_f32_16x16x32_bf16 v[116:119], v[148:151], v[64:67], v[116:119]
    v_mfma_f32_16x16x32_bf16 v[116:119], v[152:155], v[68:71], v[116:119]
    s_nop 5
    v_mfma_f32_16x16x16_bf16 v[116:119], v[156:157], v[72:73], v[116:119]
    v_cvt_pk_bf16_f32 v120, v84, v85
    v_cvt_pk_bf16_f32 v121, v86, v87
    v_cvt_pk_bf16_f32 v122, v88, v89
    v_cvt_pk_bf16_f32 v123, v90, v91
    v_cvt_pk_bf16_f32 v124, v92, v93
    v_cvt_pk_bf16_f32 v125, v94, v95
    v_cvt_pk_bf16_f32 v126, v96, v97
    v_cvt_pk_bf16_f32 v127, v98, v99
    v_cvt_pk_bf16_f32 v128, v100, v101
    v_cvt_pk_bf16_f32 v129, v102, v103
    v_cvt_pk_bf16_f32 v130, v104, v105
    v_cvt_pk_bf16_f32 v131, v106, v107
    v_cvt_pk_bf16_f32 v132, v108, v109
    v_cvt_pk_bf16_f32 v133, v110, v111
    v_cvt_pk_bf16_f32 v134, v112, v113
    v_cvt_pk_bf16_f32 v135, v114, v115
    v_cvt_pk_bf16_f32 v136, v116, v117
    v_cvt_pk_bf16_f32 v137, v118, v119
    s_lshr_b32 s60, s73, 1
    s_lshl_b32 s60, s60, 10
    s_and_b32 s61, s73, 1
    s_lshl_b32 s61, s61, 3
    s_add_u32 s60, s60, s61
    v_add_u32 v8, s60, v7
    v_lshlrev_b32 v9, 3, v0
    v_add_u32 v9, 4096, v9
    s_cmp_eq_u32 s73, 8
    s_cbranch_scc0 Lw_st
    v_mov_b32 v8, v9
Lw_st:
    s_mul_i32 s60, s71, 36864
    s_add_u32 s60, s60, 10354688
    buffer_store_dwordx2 v[120:121], v8, s[4:7], s60 offen sc1
    s_mul_i32 s60, s71, 36864
    s_add_u32 s60, s60, 10359296
    buffer_store_dwordx2 v[122:123], v8, s[4:7], s60 offen sc1
    s_mul_i32 s60, s71, 36864
    s_add_u32 s60, s60, 10363904
    buffer_store_dwordx2 v[124:125], v8, s[4:7], s60 offen sc1
    s_mul_i32 s60, s71, 36864
    s_add_u32 s60, s60, 10368512
    buffer_store_dwordx2 v[126:127], v8, s[4:7], s60 offen sc1
    s_mul_i32 s60, s71, 36864
    s_add_u32 s60, s60, 10373120
    buffer_store_dwordx2 v[128:129], v8, s[4:7], s60 offen sc1
    s_mul_i32 s60, s71, 36864
    s_add_u32 s60, s60, 10377728
    buffer_store_dwordx2 v[130:131], v8, s[4:7], s60 offen sc1
    s_mul_i32 s60, s71, 36864
    s_add_u32 s60, s60, 10382336
    buffer_store_dwordx2 v[132:133], v8, s[4:7], s60 offen sc1
    s_mul_i32 s60, s71, 36864
    s_add_u32 s60, s60, 10386944
    buffer_store_dwordx2 v[134:135], v8, s[4:7], s60 offen sc1
    s_mul_i32 s60, s71, 4608
    s_add_u32 s60, s60, 10428416
    buffer_store_dwordx2 v[136:137], v8, s[4:7], s60 offen sc1
    s_cmp_eq_u32 s73, 0
    s_cbranch_scc0 Lw_fin
    s_mov_b32 s73, 8
    s_branch Lw_round
Lw_fin:
    s_waitcnt vmcnt(0) lgkmcnt(0)
    s_barrier
    s_add_u32 s20, s58, 1
    s_mul_i32 s20, s20, 0x9e3779b1
    v_mov_b32 v8, s20
    s_cmp_eq_u32 s16, 0
    s_cbranch_scc0 Lk_done
    s_sub_u32 s60, s2, 252
    s_lshl_b32 s60, s60, 2
    s_add_u32 s60, s60, 11943936
    v_lshlrev_b32 v9, 7, v0
    s_mov_b64 exec, 0xffffffff
    buffer_store_dword v8, v9, s[4:7], s60 offen sc1
    s_mov_b64 exec, -1
    s_cmp_eq_u32 s2, 252
    s_cbranch_scc0 Lk_done
    s_mov_b32 s68, 0
    v_lshlrev_b32 v10, 10, v0
    v_min_u32 v11, 57, v0
    v_lshlrev_b32 v11, 10, v11
    v_min_u32 v12, 5, v0
    v_lshlrev_b32 v13, 2, v12
    v_add_u32 v13, 11943936, v13
    v_mov_b32 v14, 12285952
    v_mov_b32 v15, 12318208
    v_cmp_eq_u32 vcc, 4, v12
    s_nop 1
    v_cndmask_b32 v13, v13, v14, vcc
    v_cmp_eq_u32 vcc, 5, v12
    s_nop 1
    v_cndmask_b32 v13, v13, v15, vcc
Lw_poll:
    s_mov_b32 s60, 11599872
    buffer_load_dwordx2 v[24:25], v10, s[4:7], s60 offen sc1
    s_mov_b32 s60, 11665408
    buffer_load_dwordx2 v[26:27], v10, s[4:7], s60 offen sc1
    s_mov_b32 s60, 11730944
    buffer_load_dwordx2 v[28:29], v10, s[4:7], s60 offen sc1
    s_mov_b32 s60, 11796480
    buffer_load_dwordx2 v[30:31], v11, s[4:7], s60 offen sc1
    buffer_load_dword v32, v13, s[4:7], 0 offen sc1
    s_waitcnt vmcnt(0)
    v_cmp_eq_u32 vcc, s20, v32
    v_cmp_eq_u32 s[60:61], s20, v24
    s_nop 0
    s_and_b64 vcc, vcc, s[60:61]
    v_cmp_eq_u32 s[60:61], s20, v25
    s_nop 0
    s_and_b64 vcc, vcc, s[60:61]
    v_cmp_eq_u32 s[60:61], s20, v26
    s_nop 0
    s_and_b64 vcc, vcc, s[60:61]
    v_cmp_eq_u32 s[60:61], s20, v27
    s_nop 0
    s_and_b64 vcc, vcc, s[60:61]
    v_cmp_eq_u32 s[60:61], s20, v28
    s_nop 0
    s_and_b64 vcc, vcc, s[60:61]
    v_cmp_eq_u32 s[60:61], s20, v29
    s_nop 0
    s_and_b64 vcc, vcc, s[60:61]
    v_cmp_eq_u32 s[60:61], s20, v30
    s_nop 0
    s_and_b64 vcc, vcc, s[60:61]
    v_cmp_eq_u32 s[60:61], s20, v31
    s_nop 0
    s_and_b64 vcc, vcc, s[60:61]
    s_cmp_eq_u64 vcc, -1
    s_cbranch_scc1 Lw_adv
    s_sleep 32
    s_add_u32 s68, s68, 1
    s_cmp_lt_u32 s68, 200000
    s_cbranch_scc1 Lw_poll
Lw_adv:
    s_add_u32 s60, s58, 1
    v_mov_b32 v8, s60
    v_mov_b32 v9, 11534336
    s_mov_b64 exec, 1
    buffer_store_dword v8, v9, s[4:7], 0 offen sc1
    s_branch Lk_done
Lk_done:
    s_waitcnt vmcnt(0)
Lk_end:
    s_endpgm
Lf_start:
    s_waitcnt vmcnt(0) lgkmcnt(0)
    s_barrier
    s_mov_b32 s59, 1
    v_mov_b32 v0, v220
    s_mul_i32 s60, s16, 31
    s_cmp_eq_u32 s16, 0
    s_cselect_b32 s72, 0, 1
    s_add_u32 s60, s60, s72
    s_mul_i32 s61, s17, 125
    s_add_u32 s60, s60, s61
    s_mul_i32 s8, s60, 9216
    s_mov_b32 s12, s8
    s_sub_u32 s9, 32, s72
    v_and_b32 v186, 31, v0
    v_lshrrev_b32 v187, 5, v0
    v_lshlrev_b32 v188, 2, v187
    v_add_u32 v188, 0, v188
    v_xor_b32 v188, v188, v186
    v_lshlrev_b32 v188, 4, v188
    v_lshl_add_u32 v188, v187, 9, v188
    v_add_u32 v190, s13, v188
    v_add_u32 v192, 73728, v190
    v_lshlrev_b32 v188, 2, v187
    v_add_u32 v188, 8, v188
    v_xor_b32 v188, v188, v186
    v_lshlrev_b32 v188, 4, v188
    v_lshl_add_u32 v188, v187, 9, v188
    v_add_u32 v191, s13, v188
    v_add_u32 v193, 73728, v191
    v_bfe_u32 v188, v0, 4, 1
    v_bfe_u32 v189, v0, 1, 1
    v_bfe_u32 v17, v0, 2, 2
    v_and_b32 v18, 1, v0
    v_xor_b32 v16, v187, v189
    v_lshl_add_u32 v17, v16, 2, v17
    v_lshlrev_b32 v20, 9, v189
    v_lshl_add_u32 v20, v18, 3, v20
    v_add_u32 v20, s13, v20
    v_xor_b32 v19, 0, v188
    v_lshl_add_u32 v19, v19, 3, v17
    v_lshl_add_u32 v194, v19, 4, v20
    v_add_u32 v196, 73728, v194
    v_xor_b32 v19, 1, v188
    v_lshl_add_u32 v19, v19, 3, v17
    v_lshl_add_u32 v195, v19, 4, v20
    v_add_u32 v197, 73728, v195
    v_lshlrev_b32 v206, 4, v0
    v_add_u32 v207, 4096, v206
    v_add_u32 v208, 8192, v206
    v_mov_b32 v28, 0xff800000
Lf_max:
    s_add_u32 m0, s13, 0
    s_nop 0
    buffer_load_dwordx4 v206, s[4:7], s12 offen offset:0 sc1 lds
    buffer_load_dwordx4 v206, s[4:7], s12 offen offset:1024 sc1 lds
    buffer_load_dwordx4 v206, s[4:7], s12 offen offset:2048 sc1 lds
    buffer_load_dwordx4 v206, s[4:7], s12 offen offset:3072 sc1 lds
    s_add_u32 m0, s13, 4096
    s_nop 0
    buffer_load_dwordx4 v207, s[4:7], s12 offen offset:0 sc1 lds
    buffer_load_dwordx4 v207, s[4:7], s12 offen offset:1024 sc1 lds
    buffer_load_dwordx4 v207, s[4:7], s12 offen offset:2048 sc1 lds
    buffer_load_dwordx4 v207, s[4:7], s12 offen offset:3072 sc1 lds
    s_add_u32 m0, s13, 8192
    s_nop 0
    buffer_load_dwordx4 v208, s[4:7], s12 offen offset:0 sc1 lds
    s_add_u32 s12, s12, 9216
    s_waitcnt vmcnt(0)
    ds_read_b128 v[112:115], v190 offset:0
    s_waitcnt lgkmcnt(0)
    v_mfma_f32_32x32x16_bf16 v[32:47], v[112:115], a[160:163], 0
    ds_read_b128 v[116:119], v191 offset:1024
    s_waitcnt lgkmcnt(0)
    v_mfma_f32_32x32x16_bf16 v[32:47], v[116:119], a[164:167], v[32:47]
    ds_read_b128 v[120:123], v190 offset:2048
    s_waitcnt lgkmcnt(0)
    v_mfma_f32_32x32x16_bf16 v[32:47], v[120:123], a[168:171], v[32:47]
    ds_read_b128 v[112:115], v191 offset:3072
    s_waitcnt lgkmcnt(0)
    v_mfma_f32_32x32x16_bf16 v[32:47], v[112:115], a[172:175], v[32:47]
    ds_read_b128 v[116:119], v190 offset:4096
    s_waitcnt lgkmcnt(0)
    v_mfma_f32_32x32x16_bf16 v[32:47], v[116:119], a[176:179], v[32:47]
    ds_read_b128 v[120:123], v191 offset:5120
    s_waitcnt lgkmcnt(0)
    v_mfma_f32_32x32x16_bf16 v[32:47], v[120:123], a[180:183], v[32:47]
    ds_read_b128 v[112:115], v190 offset:6144
    s_waitcnt lgkmcnt(0)
    v_mfma_f32_32x32x16_bf16 v[32:47], v[112:115], a[184:187], v[32:47]
    ds_read_b128 v[116:119], v191 offset:7168
    s_waitcnt lgkmcnt(0)
    v_mfma_f32_32x32x16_bf16 v[32:47], v[116:119], a[188:191], v[32:47]
    ds_read_b128 v[120:123], v190 offset:8192
    s_waitcnt lgkmcnt(0)
    v_mfma_f32_32x32x16_bf16 v[32:47], v[120:123], a[192:195], v[32:47]
    s_nop 11
    v_max3_f32 v28, v32, v33, v28
    v_max3_f32 v28, v34, v35, v28
    v_max3_f32 v28, v36, v37, v28
    v_max3_f32 v28, v38, v39, v28
    v_max3_f32 v28, v40, v41, v28
    v_max3_f32 v28, v42, v43, v28
    v_max3_f32 v28, v44, v45, v28
    v_max3_f32 v28, v46, v47, v28
    s_sub_u32 s9, s9, 1
    s_cmp_eq_u32 s9, 0
    s_cbranch_scc0 Lf_max
    v_mov_b32 v29, v28
    v_mov_b32 v30, v28
    s_nop 1
    v_permlane32_swap_b32 v29, v30
    v_max_f32 v28, v29, v30
    v_lshlrev_b32 v29, 2, v220
    v_add_u32 v29, 149504, v29
    s_lshl_b32 s60, s16, 8
    v_add_u32 v30, s60, v29
    ds_write_b32 v30, v28
    s_waitcnt lgkmcnt(0)
    s_barrier
    ds_read_b32 v30, v29 offset:0
    ds_read_b32 v31, v29 offset:256
    ds_read_b32 v32, v29 offset:512
    ds_read_b32 v33, v29 offset:768
    s_waitcnt lgkmcnt(0)
    v_max3_f32 v28, v30, v31, v32
    v_max_f32 v28, v28, v33
    v_sub_f32 v28, 0, v28
    s_barrier
    v_mov_b32 v64, v28
    v_mov_b32 v65, v28
    v_mov_b32 v66, v28
    v_mov_b32 v67, v28
    v_mov_b32 v68, v28
    v_mov_b32 v69, v28
    v_mov_b32 v70, v28
    v_mov_b32 v71, v28
    v_mov_b32 v72, v28
    v_mov_b32 v73, v28
    v_mov_b32 v74, v28
    v_mov_b32 v75, v28
    v_mov_b32 v76, v28
    v_mov_b32 v77, v28
    v_mov_b32 v78, v28
    v_mov_b32 v79, v28
    v_mov_b32 v80, v28
    v_mov_b32 v81, v28
    v_mov_b32 v82, v28
    v_mov_b32 v83, v28
    v_mov_b32 v84, v28
    v_mov_b32 v85, v28
    v_mov_b32 v86, v28
    v_mov_b32 v87, v28
    v_mov_b32 v88, v28
    v_mov_b32 v89, v28
    v_mov_b32 v90, v28
    v_mov_b32 v91, v28
    v_mov_b32 v92, v28
    v_mov_b32 v93, v28
    v_mov_b32 v94, v28
    v_mov_b32 v95, v28
    v_mov_b32 v160, 0
    v_mov_b32 v161, 0
    v_mov_b32 v162, 0
    v_mov_b32 v163, 0
    v_mov_b32 v24, 0
    v_mov_b32 v25, 0
    v_mov_b32 v26, 0
    v_mov_b32 v27, 0
    s_nop 1
    v_mfma_f32_32x32x16_bf16 a[0:15], v[24:27], v[24:27], 0
    v_mfma_f32_32x32x16_bf16 a[16:31], v[24:27], v[24:27], 0
    v_mfma_f32_32x32x16_bf16 a[32:47], v[24:27], v[24:27], 0
    v_mfma_f32_32x32x16_bf16 a[48:63], v[24:27], v[24:27], 0
    v_mfma_f32_32x32x16_bf16 a[64:79], v[24:27], v[24:27], 0
    v_mfma_f32_32x32x16_bf16 a[80:95], v[24:27], v[24:27], 0
    v_mfma_f32_32x32x16_bf16 a[96:111], v[24:27], v[24:27], 0
    v_mfma_f32_32x32x16_bf16 a[112:127], v[24:27], v[24:27], 0
    v_mfma_f32_32x32x16_bf16 a[128:143], v[24:27], v[24:27], 0
    v_mfma_f32_32x32x16_bf16 a[144:159], v[24:27], v[24:27], 0
    s_mov_b32 s12, s8
    s_mov_b32 s14, 8
    s_cmp_eq_u32 s72, 0
    s_cselect_b32 s15, 9216, 0
    s_mov_b32 s24, s4
    s_mov_b32 s25, s5
    s_mov_b32 s26, 0
    s_mov_b32 s27, 0x00020000
    s_mov_b32 s28, s4
    s_mov_b32 s29, s5
    s_mov_b32 s30, 0
    s_mov_b32 s31, 0x00020000
    s_add_u32 m0, s13, 0
    s_nop 0
    buffer_load_dwordx4 v206, s[4:7], s12 offen offset:0 sc1 lds
    buffer_load_dwordx4 v206, s[4:7], s12 offen offset:1024 sc1 lds
    buffer_load_dwordx4 v206, s[4:7], s12 offen offset:2048 sc1 lds
    buffer_load_dwordx4 v206, s[4:7], s12 offen offset:3072 sc1 lds
    s_add_u32 m0, s13, 4096
    s_nop 0
    buffer_load_dwordx4 v207, s[4:7], s12 offen offset:0 sc1 lds
    buffer_load_dwordx4 v207, s[4:7], s12 offen offset:1024 sc1 lds
    buffer_load_dwordx4 v207, s[4:7], s12 offen offset:2048 sc1 lds
    buffer_load_dwordx4 v207, s[4:7], s12 offen offset:3072 sc1 lds
    s_add_u32 m0, s13, 8192
    s_nop 0
    buffer_load_dwordx4 v208, s[4:7], s12 offen offset:0 sc1 lds
    s_add_u32 s12, s12, s15
    s_add_u32 m0, s13, 36864
    s_nop 0
    buffer_load_dwordx4 v206, s[4:7], s12 offen offset:0 sc1 lds
    buffer_load_dwordx4 v206, s[4:7], s12 offen offset:1024 sc1 lds
    buffer_load_dwordx4 v206, s[4:7], s12 offen offset:2048 sc1 lds
    buffer_load_dwordx4 v206, s[4:7], s12 offen offset:3072 sc1 lds
    s_add_u32 m0, s13, 40960
    s_nop 0
    buffer_load_dwordx4 v207, s[4:7], s12 offen offset:0 sc1 lds
    buffer_load_dwordx4 v207, s[4:7], s12 offen offset:1024 sc1 lds
    buffer_load_dwordx4 v207, s[4:7], s12 offen offset:2048 sc1 lds
    buffer_load_dwordx4 v207, s[4:7], s12 offen offset:3072 sc1 lds
    s_add_u32 m0, s13, 45056
    s_nop 0
    buffer_load_dwordx4 v208, s[4:7], s12 offen offset:0 sc1 lds
    s_add_u32 s12, s12, 9216
    s_add_u32 m0, s13, 73728
    s_nop 0
    buffer_load_dwordx4 v206, s[4:7], s12 offen offset:0 sc1 lds
    buffer_load_dwordx4 v206, s[4:7], s12 offen offset:1024 sc1 lds
    buffer_load_dwordx4 v206, s[4:7], s12 offen offset:2048 sc1 lds
    buffer_load_dwordx4 v206, s[4:7], s12 offen offset:3072 sc1 lds
    s_add_u32 m0, s13, 77824
    s_nop 0
    buffer_load_dwordx4 v207, s[4:7], s12 offen offset:0 sc1 lds
    buffer_load_dwordx4 v207, s[4:7], s12 offen offset:1024 sc1 lds
    buffer_load_dwordx4 v207, s[4:7], s12 offen offset:2048 sc1 lds
    buffer_load_dwordx4 v207, s[4:7], s12 offen offset:3072 sc1 lds
    s_add_u32 m0, s13, 81920
    s_nop 0
    buffer_load_dwordx4 v208, s[4:7], s12 offen offset:0 sc1 lds
    s_add_u32 s12, s12, 9216
    s_waitcnt vmcnt(0)
    s_cmp_eq_u32 s72, 1
    s_cbranch_scc1 Lf_dum
    ds_read_b128 v[112:115], v190 offset:0
    s_waitcnt lgkmcnt(0)
    v_mfma_f32_32x32x16_bf16 v[0:15], v[112:115], a[160:163], v[64:79]
    v_mfma_f32_32x32x16_bf16 v[16:31], v[112:115], a[196:199], v[80:95]
    ds_read_b128 v[116:119], v191 offset:1024
    s_waitcnt lgkmcnt(0)
    v_mfma_f32_32x32x16_bf16 v[0:15], v[116:119], a[164:167], v[0:15]
    v_mfma_f32_32x32x16_bf16 v[16:31], v[116:119], a[200:203], v[16:31]
    ds_read_b128 v[120:123], v190 offset:2048
    s_waitcnt lgkmcnt(0)
    v_mfma_f32_32x32x16_bf16 v[0:15], v[120:123], a[168:171], v[0:15]
    v_mfma_f32_32x32x16_bf16 v[16:31], v[120:123], a[204:207], v[16:31]
    ds_read_b128 v[112:115], v191 offset:3072
    s_waitcnt lgkmcnt(0)
    v_mfma_f32_32x32x16_bf16 v[0:15], v[112:115], a[172:175], v[0:15]
    v_mfma_f32_32x32x16_bf16 v[16:31], v[112:115], a[208:211], v[16:31]
    ds_read_b128 v[116:119], v190 offset:4096
    s_waitcnt lgkmcnt(0)
    v_mfma_f32_32x32x16_bf16 v[0:15], v[116:119], a[176:179], v[0:15]
    v_mfma_f32_32x32x16_bf16 v[16:31], v[116:119], a[212:215], v[16:31]
    ds_read_b128 v[120:123], v191 offset:5120
    s_waitcnt lgkmcnt(0)
    v_mfma_f32_32x32x16_bf16 v[0:15], v[120:123], a[180:183], v[0:15]
    v_mfma_f32_32x32x16_bf16 v[16:31], v[120:123], a[216:219], v[16:31]
    ds_read_b128 v[112:115], v190 offset:6144
    s_waitcnt lgkmcnt(0)
    v_mfma_f32_32x32x16_bf16 v[0:15], v[112:115], a[184:187], v[0:15]
    v_mfma_f32_32x32x16_bf16 v[16:31], v[112:115], a[220:223], v[16:31]
    ds_read_b128 v[116:119], v191 offset:7168
    s_waitcnt lgkmcnt(0)
    v_mfma_f32_32x32x16_bf16 v[0:15], v[116:119], a[188:191], v[0:15]
    v_mfma_f32_32x32x16_bf16 v[16:31], v[116:119], a[224:227], v[16:31]
    ds_read_b128 v[120:123], v190 offset:8192
    s_waitcnt lgkmcnt(0)
    v_mfma_f32_32x32x16_bf16 v[0:15], v[120:123], a[192:195], v[0:15]
    v_mfma_f32_32x32x16_bf16 v[16:31], v[120:123], a[228:231], v[16:31]
    s_nop 7
    s_nop 7
    ds_read_b64_tr_b16 v[124:125], v194 offset:0
    ds_read_b64_tr_b16 v[126:127], v194 offset:256
    ds_read_b64_tr_b16 v[128:129], v195 offset:1024
    ds_read_b64_tr_b16 v[130:131], v195 offset:1280
    ds_read_b64_tr_b16 v[132:133], v194 offset:2048
    ds_read_b64_tr_b16 v[134:135], v194 offset:2304
    ds_read_b64_tr_b16 v[136:137], v195 offset:3072
    ds_read_b128 v[112:115], v190 offset:36864
    ds_read_b64_tr_b16 v[138:139], v195 offset:3328
    ds_read_b64_tr_b16 v[140:141], v194 offset:4096
    ds_read_b128 v[116:119], v191 offset:37888
    ds_read_b64_tr_b16 v[142:143], v194 offset:4352
    ds_read_b64_tr_b16 v[144:145], v195 offset:5120
    ds_read_b128 v[120:123], v190 offset:38912
    ds_read_b64_tr_b16 v[146:147], v195 offset:5376
    ds_read_b64_tr_b16 v[148:149], v194 offset:6144
    ds_read_b64_tr_b16 v[150:151], v194 offset:6400
    ds_read_b64_tr_b16 v[152:153], v195 offset:7168
    ds_read_b64_tr_b16 v[154:155], v195 offset:7424
    s_branch Lk_loop
Lf_dum:
    ds_read_b128 v[112:115], v190 offset:36864
    ds_read_b128 v[116:119], v191 offset:37888
    ds_read_b128 v[120:123], v190 offset:38912
    s_waitcnt lgkmcnt(0)
    s_waitcnt lgkmcnt(11)
    v_mfma_f32_32x32x16_bf16 v[32:47], v[112:115], a[160:163], v[64:79]
    v_mfma_f32_32x32x16_bf16 v[48:63], v[112:115], a[196:199], v[80:95]
    ds_read_b128 v[112:115], v191 offset:39936
    s_waitcnt lgkmcnt(9)
    v_mfma_f32_32x32x16_bf16 v[32:47], v[116:119], a[164:167], v[32:47]
    v_mfma_f32_32x32x16_bf16 v[48:63], v[116:119], a[200:203], v[48:63]
    ds_read_b128 v[116:119], v190 offset:40960
    s_waitcnt lgkmcnt(7)
    v_mfma_f32_32x32x16_bf16 v[32:47], v[120:123], a[168:171], v[32:47]
    v_mfma_f32_32x32x16_bf16 v[48:63], v[120:123], a[204:207], v[48:63]
    ds_read_b128 v[120:123], v191 offset:41984
    s_waitcnt lgkmcnt(2)
    v_mfma_f32_32x32x16_bf16 v[32:47], v[112:115], a[172:175], v[32:47]
    v_mfma_f32_32x32x16_bf16 v[48:63], v[112:115], a[208:211], v[48:63]
    ds_read_b128 v[112:115], v190 offset:43008
    s_waitcnt lgkmcnt(2)
    v_mfma_f32_32x32x16_bf16 v[32:47], v[116:119], a[176:179], v[32:47]
    v_mfma_f32_32x32x16_bf16 v[48:63], v[116:119], a[212:215], v[48:63]
    ds_read_b128 v[116:119], v191 offset:44032
    s_waitcnt lgkmcnt(2)
    v_mfma_f32_32x32x16_bf16 v[32:47], v[120:123], a[180:183], v[32:47]
    v_mfma_f32_32x32x16_bf16 v[48:63], v[120:123], a[216:219], v[48:63]
    ds_read_b128 v[120:123], v190 offset:45056
    s_waitcnt lgkmcnt(2)
    v_mfma_f32_32x32x16_bf16 v[32:47], v[112:115], a[184:187], v[32:47]
    v_mfma_f32_32x32x16_bf16 v[48:63], v[112:115], a[220:223], v[48:63]
    s_waitcnt lgkmcnt(1)
    v_mfma_f32_32x32x16_bf16 v[32:47], v[116:119], a[188:191], v[32:47]
    v_mfma_f32_32x32x16_bf16 v[48:63], v[116:119], a[224:227], v[48:63]
    s_waitcnt lgkmcnt(0)
    v_mfma_f32_32x32x16_bf16 v[32:47], v[120:123], a[192:195], v[32:47]
    v_mfma_f32_32x32x16_bf16 v[48:63], v[120:123], a[228:231], v[48:63]
    s_add_u32 m0, s13, 110592
    s_nop 0
    buffer_load_dwordx4 v206, s[4:7], s12 offen offset:0 sc1 lds
    buffer_load_dwordx4 v206, s[4:7], s12 offen offset:1024 sc1 lds
    buffer_load_dwordx4 v206, s[4:7], s12 offen offset:2048 sc1 lds
    buffer_load_dwordx4 v206, s[4:7], s12 offen offset:3072 sc1 lds
    s_add_u32 m0, s13, 114688
    s_nop 0
    buffer_load_dwordx4 v207, s[4:7], s12 offen offset:0 sc1 lds
    buffer_load_dwordx4 v207, s[4:7], s12 offen offset:1024 sc1 lds
    buffer_load_dwordx4 v207, s[4:7], s12 offen offset:2048 sc1 lds
    ds_read_b64_tr_b16 v[124:125], v194 offset:36864
    ds_read_b64_tr_b16 v[126:127], v194 offset:37120
    buffer_load_dwordx4 v207, s[4:7], s12 offen offset:3072 sc1 lds
    ds_read_b64_tr_b16 v[128:129], v195 offset:37888
    s_add_u32 m0, s13, 118784
    ds_read_b64_tr_b16 v[130:131], v195 offset:38144
    buffer_load_dwordx4 v208, s[4:7], s12 offen offset:0 sc1 lds
    ds_read_b64_tr_b16 v[132:133], v194 offset:38912
    s_add_u32 s12, s12, 9216
    ds_read_b64_tr_b16 v[134:135], v194 offset:39168
    ds_read_b64_tr_b16 v[136:137], v195 offset:39936
    s_waitcnt vmcnt(9)
    ds_read_b128 v[112:115], v192 offset:0
    ds_read_b64_tr_b16 v[138:139], v195 offset:40192
    ds_read_b64_tr_b16 v[140:141], v194 offset:40960
    buffer_load_dword v210, v216, s[24:27], 0 offen sc1
    ds_read_b128 v[116:119], v193 offset:1024
    ds_read_b64_tr_b16 v[142:143], v194 offset:41216
    ds_read_b64_tr_b16 v[144:145], v195 offset:41984
    ds_read_b128 v[120:123], v192 offset:2048
    ds_read_b64_tr_b16 v[146:147], v195 offset:42240
    ds_read_b64_tr_b16 v[148:149], v194 offset:43008
    ds_read_b64_tr_b16 v[150:151], v194 offset:43264
    ds_read_b64_tr_b16 v[152:153], v195 offset:44032
    ds_read_b64_tr_b16 v[154:155], v195 offset:44288
    s_nop 7
    s_nop 3
    s_branch Lk_b1
.section .rodata,"a"
.p2align 6
.amdhsa_kernel standalone__conformer_family_branchformer__speech_kernel
  .amdhsa_next_free_vgpr 512
  .amdhsa_next_free_sgpr 102
  .amdhsa_accum_offset 256
  .amdhsa_group_segment_fixed_size 0
  .amdhsa_kernarg_size 96
  .amdhsa_user_sgpr_count 2
  .amdhsa_user_sgpr_kernarg_segment_ptr 1
  .amdhsa_system_sgpr_workgroup_id_x 1
  .amdhsa_float_denorm_mode_32 3
.end_amdhsa_kernel
```
